```python
import torch

def _softmax(x, axis=-1):
    return torch.softmax(x, dim=axis)
def _gelu(x):
    return torch.nn.functional.gelu(x, approximate="tanh")
def _silu(x):
    return torch.nn.functional.silu(x)
def _sigmoid(x):
    return torch.sigmoid(x)
def _layernorm(x, axis=-1, eps=1e-5):
    m = x.mean(dim=axis, keepdim=True)
    v = x.var(dim=axis, keepdim=True, unbiased=False)
    return (x - m) / torch.sqrt(v + eps)
def _scatter_add(tgt, idx, src, axis=0):
    return tgt.clone().index_add_(axis, idx, src)
def _segment_sum(src, seg, n):
    out = torch.zeros((n,) + src.shape[1:], dtype=src.dtype)
    return out.index_add_(0, seg, src)
def _pad(x, pw):
    flat = tuple(v for pair in reversed(pw) for v in pair)
    return torch.nn.functional.pad(x, flat)

kernel_name = 'sequential_preLN__gqa_block_cached__dense_activation_silu__decode'

def setup_inputs():

    _w = (lambda a: (lambda t: t.to(torch.bfloat16) if t.is_floating_point() else t)(torch.as_tensor(a)))
    def _A_setup():
        B, Sq, D = 2, 1, 448
        Hq, Hkv, Sk, Dh = 16, 8, 4096, 256
        assert Hq % Hkv == 0, (Hq, Hkv)
        return {
            "x": _w((lambda *s: torch.randn(*s, dtype=torch.bfloat16) * 0.1)(B, Sq, D)),
            "k_cache": _w((lambda *s: torch.randn(*s, dtype=torch.bfloat16) * 1.6)(B, Hkv, Sk, Dh)),
            "v_cache": _w((lambda *s: torch.randn(*s, dtype=torch.bfloat16) * 1.6)(B, Hkv, Sk, Dh)),
            "wq": _w((lambda *s: torch.randn(*s, dtype=torch.bfloat16) * 1.6)(D, Hq * Dh) * (D ** -0.5)),
            "wo": _w((lambda *s: torch.randn(*s, dtype=torch.bfloat16) * 1.6)(Hq * Dh, D) * ((Hq * Dh) ** -0.5)),
        }
    _A_in = _A_setup()

    def _B_setup():
        B, S, D, F = 2, 1, 448, 1792
        return {
            "x": _w((lambda *s: torch.randn(*s, dtype=torch.bfloat16) * 0.1)(B, S, D)),
            "w1": _w((lambda *s: torch.randn(*s, dtype=torch.bfloat16) * 3.2)(D, F) * (D ** -0.5)),
            "w2": _w((lambda *s: torch.randn(*s, dtype=torch.bfloat16) * 3.2)(F, D) * (F ** -0.5)),
        }
    _B_in = _B_setup()

    return {
        "A_x": _A_in["x"],
        "A_k_cache": _A_in["k_cache"],
        "A_v_cache": _A_in["v_cache"],
        "A_wq": _A_in["wq"],
        "A_wo": _A_in["wo"],
        "B_x": _B_in["x"],
        "B_w1": _B_in["w1"],
        "B_w2": _B_in["w2"],
    }

def reference(A_x, A_k_cache, A_v_cache, A_wq, A_wo, B_x, B_w1, B_w2):
    def _A_ref(x, k_cache, v_cache, wq, wo):
        B, Sq, D = x.shape
        Hq, Dh = 16, 256
        Hkv = k_cache.shape[1]
        rep = Hq // Hkv
        q = (lambda x, *d: x.permute(*d))((x @ wq).reshape(B, Sq, Hq, Dh), 0, 2, 1, 3)
        k = (lambda x, n, axis: torch.repeat_interleave(x, n, dim=axis))(k_cache, rep, axis=1)
        v = (lambda x, n, axis: torch.repeat_interleave(x, n, dim=axis))(v_cache, rep, axis=1)
        scores = torch.einsum("bhqd,bhkd->bhqk", q, k) * (Dh ** -0.5)
        p = _softmax(scores, axis=-1)
        o = torch.einsum("bhqk,bhkd->bhqd", p, v)
        return (lambda x, *d: x.permute(*d))(o, 0, 2, 1, 3).reshape(B, Sq, Hq * Dh) @ wo

    def _B_ref(x, w1, w2):
        h = torch.einsum("bsd,df->bsf", x, w1)
        h = _silu(h)
        out = torch.einsum("bsf,fd->bsd", h, w2)
        return out

    x = A_x
    h = x + _A_ref(_layernorm(x, axis=-1), A_k_cache, A_v_cache, A_wq, A_wo)
    h2 = h + _B_ref(_layernorm(h, axis=-1), B_w1, B_w2)
    return h2
```

```asm
; @launch grid=(256,1,1) block=(576,1,1) lds=144384
.amdgcn_target "amdgcn-amd-amdhsa--gfx950"
.text
.globl sequential_preLN__gqa_block_cached__dense_activation_silu__decode_kernel
.p2align 8
.type sequential_preLN__gqa_block_cached__dense_activation_silu__decode_kernel,@function
sequential_preLN__gqa_block_cached__dense_activation_silu__decode_kernel:
    s_cmp_ge_u32 s2, 256
    s_cbranch_scc1 L_end
    s_load_dwordx16 s[4:19], s[0:1], 0
    s_load_dwordx4 s[20:23], s[0:1], 64
    s_load_dwordx2 s[24:25], s[0:1], 80
    v_lshrrev_b32 v3, 6, v0
    s_nop 0
    v_readfirstlane_b32 s3, v3
    v_and_b32 v1, 63, v0
L_pcref:
    s_getpc_b64 s[26:27]
    s_sub_u32 s26, s26, (L_pcref + 4 - sequential_preLN__gqa_block_cached__dense_activation_silu__decode_kernel)
    s_subb_u32 s27, s27, 0
    v_lshlrev_b32 v2, 7, v0
    v_mov_b32 v3, 0
    v_mov_b32 v5, s27
    v_add_co_u32 v4, vcc, s26, v2
    s_nop 1
    v_addc_co_u32 v5, vcc, v5, v3, vcc
    v_cmp_gt_u32 vcc, (L_code_end - sequential_preLN__gqa_block_cached__dense_activation_silu__decode_kernel), v2
    s_nop 0
    s_and_saveexec_b64 s[28:29], vcc
    s_cbranch_execz L_touch_done
    global_load_dword v166, v[4:5], off
L_touch_done:
    s_mov_b64 exec, -1
    s_and_b32 s73, s2, 7
    s_lshr_b32 s91, s2, 3
    s_lshr_b32 s72, s2, 7
    s_and_b32 s74, s91, 15
    s_cmp_ge_u32 s91, 14
    s_cselect_b32 s78, 1, 0
    s_lshl_b32 s75, s73, 1
    s_add_u32 s75, s75, s78
    s_mul_i32 s78, s78, 14
    s_sub_u32 s76, s91, s78
    s_lshl_b32 s77, s73, 2
    s_add_u32 s77, s77, s91
    s_sub_u32 s77, s77, 28
    s_cmp_ge_u32 s91, 28
    s_cselect_b32 s100, 1, 0
    s_cmp_lt_u32 s73, 7
    s_cselect_b32 s100, s100, 0
    s_cmp_lt_u32 s77, 14
    s_cselect_b32 s78, 1, 0
    s_lshl_b32 s100, s100, s78
    s_mov_b64 s[98:99], -1
    s_mov_b32 s68, 0
    s_mov_b32 s69, 4096
    s_mov_b32 s70, 8192
    s_mov_b32 s71, 12288
    s_mov_b32 s80, 0xcccccccc
    s_mov_b32 s81, 0xcccccccc
    s_mov_b32 s82, 0xaaaaaaaa
    s_mov_b32 s83, 0xaaaaaaaa
    s_mov_b32 s86, 0x3db8aa3b
    s_mov_b32 s87, 400000
    s_memrealtime s[96:97]
    s_waitcnt lgkmcnt(0)
    s_or_b32 s97, s2, s3
    s_cmp_lg_u32 s97, 0
    s_cbranch_scc1 L_nonce_done
    s_and_b32 s96, s96, 0x7fffffff
    s_or_b32 s96, s96, 1
    v_mov_b32 v8, s96
    v_mov_b32 v9, 0
    s_mov_b64 exec, 1
    global_store_dword v9, v8, s[22:23] sc1
    s_mov_b64 exec, -1
L_nonce_done:
    s_mov_b32 s28, s6
    s_mov_b32 s29, s7
    s_mov_b32 s30, 33554432
    s_mov_b32 s31, 0x00020000
    s_mov_b32 s32, s8
    s_mov_b32 s33, s9
    s_mov_b32 s34, 33554432
    s_mov_b32 s35, 0x00020000
    s_mov_b32 s36, s24
    s_mov_b32 s37, s25
    s_mov_b32 s38, 268435456
    s_mov_b32 s39, 0x00020000
    s_mov_b32 s40, s10
    s_mov_b32 s41, s11
    s_mov_b32 s42, 3670016
    s_mov_b32 s43, 0x00020000
    s_mov_b32 s44, s12
    s_mov_b32 s45, s13
    s_mov_b32 s46, 3670016
    s_mov_b32 s47, 0x00020000
    s_mov_b32 s48, s16
    s_mov_b32 s49, s17
    s_mov_b32 s50, 1605632
    s_mov_b32 s51, 0x00020000
    s_mov_b32 s52, s18
    s_mov_b32 s53, s19
    s_mov_b32 s54, 1605632
    s_mov_b32 s55, 0x00020000
    s_mov_b32 s56, s4
    s_mov_b32 s57, s5
    s_mov_b32 s58, 1792
    s_mov_b32 s59, 0x00020000
    s_mov_b32 s60, s20
    s_mov_b32 s61, s21
    s_mov_b32 s62, 1792
    s_mov_b32 s63, 0x00020000
    s_mov_b32 s64, s22
    s_mov_b32 s65, s23
    s_mov_b32 s66, 256
    s_mov_b32 s67, 0x00020000
    s_cmp_lt_u32 s91, 28
    s_cselect_b32 s46, s46, 0
    s_cmp_eq_u32 s3, 8
    s_cbranch_scc1 L_aux
    v_lshlrev_b32 v2, 4, v1
    s_lshl_b32 s78, s72, 3
    s_add_u32 s78, s78, s73
    s_lshl_b32 s78, s78, 4
    s_add_u32 s78, s78, s74
    s_lshl_b32 s78, s78, 17
    s_lshl_b32 s79, s3, 14
    s_add_u32 s78, s78, s79
    v_add_u32 v2, s78, v2
    buffer_load_dwordx4 v[8:11], v2, s[28:31], s68 offen offset:0 nt
    s_waitcnt vmcnt(0)
    buffer_load_dwordx4 v[12:15], v2, s[28:31], s68 offen offset:1024 nt
    v_mov_b32 v144, 0
    v_mov_b32 v145, 0
    v_mov_b32 v146, 0
    v_mov_b32 v147, 0
    v_mov_b32 v148, 0
    v_mov_b32 v149, 0
    v_mov_b32 v150, 0
    v_mov_b32 v151, 0
    v_mov_b32 v152, 0
    v_mov_b32 v153, 0
    v_mov_b32 v154, 0
    v_mov_b32 v155, 0
    v_mov_b32 v156, 0
    v_mov_b32 v157, 0
    v_mov_b32 v158, 0
    v_mov_b32 v159, 0
    v_lshlrev_b32 v7, 2, v0
    v_mov_b32 v3, 0x3f803f80
    v_min_u32 v7, 892, v7
    ds_write_b32 v7, v3 offset:10752
    v_and_b32 v3, 31, v1
    v_lshlrev_b32 v3, 4, v3
    v_lshrrev_b32 v4, 5, v1
    v_lshlrev_b32 v4, 7, v4
    s_lshl_b32 s78, s3, 8
    v_add_u32 v4, s78, v4
    v_and_b32 v5, 15, v1
    v_lshl_add_u32 v5, v5, 3, v4
    v_bfe_u32 v6, v1, 4, 1
    v_lshl_add_u32 v5, v6, 2, v5
    v_lshlrev_b32 v6, 5, v6
    s_lshl_b32 s78, s3, 2
    v_add_u32 v6, s78, v6
    s_waitcnt vmcnt(0)
    buffer_load_dwordx4 v[16:19], v2, s[28:31], s68 offen offset:2048 nt
    buffer_load_dwordx4 v[20:23], v2, s[28:31], s68 offen offset:3072 nt
    buffer_load_dwordx4 v[24:27], v2, s[28:31], s69 offen offset:0 nt
    s_waitcnt vmcnt(2)
    buffer_load_dwordx4 v[28:31], v2, s[28:31], s69 offen offset:1024 nt
    s_waitcnt vmcnt(2)
    buffer_load_dwordx4 v[32:35], v2, s[28:31], s69 offen offset:2048 nt
    s_waitcnt vmcnt(2)
    buffer_load_dwordx4 v[36:39], v2, s[28:31], s69 offen offset:3072 nt
    s_waitcnt vmcnt(2)
    buffer_load_dwordx4 v[40:43], v2, s[28:31], s70 offen offset:0 nt
    s_waitcnt vmcnt(2)
    buffer_load_dwordx4 v[44:47], v2, s[28:31], s70 offen offset:1024 nt
    s_waitcnt vmcnt(2)
    buffer_load_dwordx4 v[48:51], v2, s[28:31], s70 offen offset:2048 nt
    s_waitcnt vmcnt(2)
    buffer_load_dwordx4 v[52:55], v2, s[28:31], s70 offen offset:3072 nt
    s_waitcnt vmcnt(2)
    buffer_load_dwordx4 v[56:59], v2, s[28:31], s71 offen offset:0 nt
    s_waitcnt vmcnt(2)
    buffer_load_dwordx4 v[60:63], v2, s[28:31], s71 offen offset:1024 nt
    s_waitcnt vmcnt(2)
    buffer_load_dwordx4 v[64:67], v2, s[28:31], s71 offen offset:2048 nt
    s_waitcnt vmcnt(2)
    buffer_load_dwordx4 v[68:71], v2, s[28:31], s71 offen offset:3072 nt
    s_waitcnt vmcnt(2)
    buffer_load_dwordx4 v[72:75], v2, s[32:35], s68 offen offset:0 nt
    s_waitcnt vmcnt(2)
    buffer_load_dwordx4 v[76:79], v2, s[32:35], s68 offen offset:1024 nt
    buffer_load_dwordx4 v[80:83], v2, s[32:35], s68 offen offset:2048 nt
    s_waitcnt lgkmcnt(0)
    s_barrier
    ds_read_b128 v[136:139], v3 offset:0
    ds_read_b128 v[140:143], v3 offset:512
    s_waitcnt lgkmcnt(0)
    s_waitcnt vmcnt(3)
L_seg0:
    v_dot2_f32_bf16 v160, v8, v136, 0
    v_dot2_f32_bf16 v161, v8, v140, 0
    v_dot2_f32_bf16 v162, v12, v136, 0
    v_dot2_f32_bf16 v163, v12, v140, 0
    v_dot2_f32_bf16 v160, v9, v137, v160
    v_dot2_f32_bf16 v161, v9, v141, v161
    v_dot2_f32_bf16 v162, v13, v137, v162
    v_dot2_f32_bf16 v163, v13, v141, v163
    v_dot2_f32_bf16 v160, v10, v138, v160
    v_dot2_f32_bf16 v161, v10, v142, v161
    v_dot2_f32_bf16 v162, v14, v138, v162
    v_dot2_f32_bf16 v163, v14, v142, v163
    v_dot2_f32_bf16 v8, v11, v139, v160
    v_dot2_f32_bf16 v9, v11, v143, v161
    v_dot2_f32_bf16 v12, v15, v139, v162
    v_dot2_f32_bf16 v13, v15, v143, v163
    v_dot2_f32_bf16 v160, v16, v136, 0
    v_dot2_f32_bf16 v161, v16, v140, 0
    v_dot2_f32_bf16 v162, v20, v136, 0
    v_dot2_f32_bf16 v163, v20, v140, 0
    v_dot2_f32_bf16 v160, v17, v137, v160
    v_dot2_f32_bf16 v161, v17, v141, v161
    v_dot2_f32_bf16 v162, v21, v137, v162
    v_dot2_f32_bf16 v163, v21, v141, v163
    v_dot2_f32_bf16 v160, v18, v138, v160
    v_dot2_f32_bf16 v161, v18, v142, v161
    v_dot2_f32_bf16 v162, v22, v138, v162
    v_dot2_f32_bf16 v163, v22, v142, v163
    v_dot2_f32_bf16 v16, v19, v139, v160
    v_dot2_f32_bf16 v17, v19, v143, v161
    v_dot2_f32_bf16 v20, v23, v139, v162
    v_dot2_f32_bf16 v21, v23, v143, v163
    v_dot2_f32_bf16 v160, v24, v136, 0
    v_dot2_f32_bf16 v161, v24, v140, 0
    v_dot2_f32_bf16 v162, v28, v136, 0
    v_dot2_f32_bf16 v163, v28, v140, 0
    v_dot2_f32_bf16 v160, v25, v137, v160
    v_dot2_f32_bf16 v161, v25, v141, v161
    v_dot2_f32_bf16 v162, v29, v137, v162
    v_dot2_f32_bf16 v163, v29, v141, v163
    v_dot2_f32_bf16 v160, v26, v138, v160
    v_dot2_f32_bf16 v161, v26, v142, v161
    v_dot2_f32_bf16 v162, v30, v138, v162
    v_dot2_f32_bf16 v163, v30, v142, v163
    v_dot2_f32_bf16 v24, v27, v139, v160
    v_dot2_f32_bf16 v25, v27, v143, v161
    v_dot2_f32_bf16 v28, v31, v139, v162
    v_dot2_f32_bf16 v29, v31, v143, v163
    v_dot2_f32_bf16 v160, v32, v136, 0
    v_dot2_f32_bf16 v161, v32, v140, 0
    v_dot2_f32_bf16 v162, v36, v136, 0
    v_dot2_f32_bf16 v163, v36, v140, 0
    v_dot2_f32_bf16 v160, v33, v137, v160
    v_dot2_f32_bf16 v161, v33, v141, v161
    v_dot2_f32_bf16 v162, v37, v137, v162
    v_dot2_f32_bf16 v163, v37, v141, v163
    v_dot2_f32_bf16 v160, v34, v138, v160
    v_dot2_f32_bf16 v161, v34, v142, v161
    v_dot2_f32_bf16 v162, v38, v138, v162
    v_dot2_f32_bf16 v163, v38, v142, v163
    v_dot2_f32_bf16 v32, v35, v139, v160
    v_dot2_f32_bf16 v33, v35, v143, v161
    v_dot2_f32_bf16 v36, v39, v139, v162
    v_dot2_f32_bf16 v37, v39, v143, v163
    v_dot2_f32_bf16 v160, v40, v136, 0
    v_dot2_f32_bf16 v161, v40, v140, 0
    v_dot2_f32_bf16 v162, v44, v136, 0
    v_dot2_f32_bf16 v163, v44, v140, 0
    v_dot2_f32_bf16 v160, v41, v137, v160
    v_dot2_f32_bf16 v161, v41, v141, v161
    v_dot2_f32_bf16 v162, v45, v137, v162
    v_dot2_f32_bf16 v163, v45, v141, v163
    v_dot2_f32_bf16 v160, v42, v138, v160
    v_dot2_f32_bf16 v161, v42, v142, v161
    v_dot2_f32_bf16 v162, v46, v138, v162
    v_dot2_f32_bf16 v163, v46, v142, v163
    v_dot2_f32_bf16 v40, v43, v139, v160
    v_dot2_f32_bf16 v41, v43, v143, v161
    v_dot2_f32_bf16 v44, v47, v139, v162
    v_dot2_f32_bf16 v45, v47, v143, v163
    v_dot2_f32_bf16 v160, v48, v136, 0
    v_dot2_f32_bf16 v161, v48, v140, 0
    v_dot2_f32_bf16 v162, v52, v136, 0
    v_dot2_f32_bf16 v163, v52, v140, 0
    v_dot2_f32_bf16 v160, v49, v137, v160
    v_dot2_f32_bf16 v161, v49, v141, v161
    v_dot2_f32_bf16 v162, v53, v137, v162
    v_dot2_f32_bf16 v163, v53, v141, v163
    v_dot2_f32_bf16 v160, v50, v138, v160
    v_dot2_f32_bf16 v161, v50, v142, v161
    v_dot2_f32_bf16 v162, v54, v138, v162
    v_dot2_f32_bf16 v163, v54, v142, v163
    v_dot2_f32_bf16 v48, v51, v139, v160
    v_dot2_f32_bf16 v49, v51, v143, v161
    v_dot2_f32_bf16 v52, v55, v139, v162
    v_dot2_f32_bf16 v53, v55, v143, v163
    v_dot2_f32_bf16 v160, v56, v136, 0
    v_dot2_f32_bf16 v161, v56, v140, 0
    v_dot2_f32_bf16 v162, v60, v136, 0
    v_dot2_f32_bf16 v163, v60, v140, 0
    v_dot2_f32_bf16 v160, v57, v137, v160
    v_dot2_f32_bf16 v161, v57, v141, v161
    v_dot2_f32_bf16 v162, v61, v137, v162
    v_dot2_f32_bf16 v163, v61, v141, v163
    v_dot2_f32_bf16 v160, v58, v138, v160
    v_dot2_f32_bf16 v161, v58, v142, v161
    v_dot2_f32_bf16 v162, v62, v138, v162
    v_dot2_f32_bf16 v163, v62, v142, v163
    v_dot2_f32_bf16 v56, v59, v139, v160
    v_dot2_f32_bf16 v57, v59, v143, v161
    v_dot2_f32_bf16 v60, v63, v139, v162
    v_dot2_f32_bf16 v61, v63, v143, v163
    v_dot2_f32_bf16 v160, v64, v136, 0
    v_dot2_f32_bf16 v161, v64, v140, 0
    v_dot2_f32_bf16 v162, v68, v136, 0
    v_dot2_f32_bf16 v163, v68, v140, 0
    v_dot2_f32_bf16 v160, v65, v137, v160
    v_dot2_f32_bf16 v161, v65, v141, v161
    v_dot2_f32_bf16 v162, v69, v137, v162
    v_dot2_f32_bf16 v163, v69, v141, v163
    v_dot2_f32_bf16 v160, v66, v138, v160
    v_dot2_f32_bf16 v161, v66, v142, v161
    v_dot2_f32_bf16 v162, v70, v138, v162
    v_dot2_f32_bf16 v163, v70, v142, v163
    v_dot2_f32_bf16 v64, v67, v139, v160
    v_dot2_f32_bf16 v65, v67, v143, v161
    v_dot2_f32_bf16 v68, v71, v139, v162
    v_dot2_f32_bf16 v69, v71, v143, v163
    v_permlane16_swap_b32 v8, v9
    v_permlane16_swap_b32 v12, v13
    v_permlane16_swap_b32 v16, v17
    v_permlane16_swap_b32 v20, v21
    v_permlane16_swap_b32 v24, v25
    v_permlane16_swap_b32 v28, v29
    v_permlane16_swap_b32 v32, v33
    v_permlane16_swap_b32 v36, v37
    v_permlane16_swap_b32 v40, v41
    v_permlane16_swap_b32 v44, v45
    v_permlane16_swap_b32 v48, v49
    v_permlane16_swap_b32 v52, v53
    v_permlane16_swap_b32 v56, v57
    v_permlane16_swap_b32 v60, v61
    v_permlane16_swap_b32 v64, v65
    v_permlane16_swap_b32 v68, v69
    v_add_f32 v8, v8, v9
    v_add_f32 v12, v12, v13
    v_add_f32 v16, v16, v17
    v_add_f32 v20, v20, v21
    v_add_f32 v24, v24, v25
    v_add_f32 v28, v28, v29
    v_add_f32 v32, v32, v33
    v_add_f32 v36, v36, v37
    v_add_f32 v40, v40, v41
    v_add_f32 v44, v44, v45
    v_add_f32 v48, v48, v49
    v_add_f32 v52, v52, v53
    v_add_f32 v56, v56, v57
    v_add_f32 v60, v60, v61
    v_add_f32 v64, v64, v65
    v_add_f32 v68, v68, v69
    v_add_f32_dpp v8, v8, v8 row_ror:8 row_mask:0xf bank_mask:0x3
    v_add_f32_dpp v12, v12, v12 row_ror:8 row_mask:0xf bank_mask:0x3
    v_add_f32_dpp v16, v16, v16 row_ror:8 row_mask:0xf bank_mask:0x3
    v_add_f32_dpp v20, v20, v20 row_ror:8 row_mask:0xf bank_mask:0x3
    v_add_f32_dpp v24, v24, v24 row_ror:8 row_mask:0xf bank_mask:0x3
    v_add_f32_dpp v28, v28, v28 row_ror:8 row_mask:0xf bank_mask:0x3
    v_add_f32_dpp v32, v32, v32 row_ror:8 row_mask:0xf bank_mask:0x3
    v_add_f32_dpp v36, v36, v36 row_ror:8 row_mask:0xf bank_mask:0x3
    v_add_f32_dpp v8, v40, v40 row_ror:8 row_mask:0xf bank_mask:0xc
    v_add_f32_dpp v12, v44, v44 row_ror:8 row_mask:0xf bank_mask:0xc
    v_add_f32_dpp v16, v48, v48 row_ror:8 row_mask:0xf bank_mask:0xc
    v_add_f32_dpp v20, v52, v52 row_ror:8 row_mask:0xf bank_mask:0xc
    v_add_f32_dpp v24, v56, v56 row_ror:8 row_mask:0xf bank_mask:0xc
    v_add_f32_dpp v28, v60, v60 row_ror:8 row_mask:0xf bank_mask:0xc
    v_add_f32_dpp v32, v64, v64 row_ror:8 row_mask:0xf bank_mask:0xc
    v_add_f32_dpp v36, v68, v68 row_ror:8 row_mask:0xf bank_mask:0xc
    v_add_f32_dpp v8, v8, v8 row_shl:4 row_mask:0xf bank_mask:0x5
    v_add_f32_dpp v12, v12, v12 row_shl:4 row_mask:0xf bank_mask:0x5
    v_add_f32_dpp v16, v16, v16 row_shl:4 row_mask:0xf bank_mask:0x5
    v_add_f32_dpp v20, v20, v20 row_shl:4 row_mask:0xf bank_mask:0x5
    v_add_f32_dpp v8, v24, v24 row_shr:4 row_mask:0xf bank_mask:0xa
    v_add_f32_dpp v12, v28, v28 row_shr:4 row_mask:0xf bank_mask:0xa
    v_add_f32_dpp v16, v32, v32 row_shr:4 row_mask:0xf bank_mask:0xa
    v_add_f32_dpp v20, v36, v36 row_shr:4 row_mask:0xf bank_mask:0xa
    v_cndmask_b32 v160, v8, v16, s[80:81]
    v_cndmask_b32 v161, v16, v8, s[80:81]
    v_cndmask_b32 v162, v12, v20, s[80:81]
    v_cndmask_b32 v163, v20, v12, s[80:81]
    v_add_f32_dpp v8, v161, v160 quad_perm:[2,3,0,1] row_mask:0xf bank_mask:0xf
    s_nop 0
    v_add_f32_dpp v12, v163, v162 quad_perm:[2,3,0,1] row_mask:0xf bank_mask:0xf
    v_cndmask_b32 v160, v8, v12, s[82:83]
    v_cndmask_b32 v161, v12, v8, s[82:83]
    s_nop 1
    v_add_f32_dpp v164, v161, v160 quad_perm:[1,0,3,2] row_mask:0xf bank_mask:0xf
    v_cvt_pk_bf16_f32 v164, v164, v164
    v_lshlrev_b32 v164, 16, v164
    v_mov_b32 v165, v164
    s_nop 1
    v_max_f32_dpp v165, v165, v165 quad_perm:[1,0,3,2] row_mask:0xf bank_mask:0xf
    s_nop 1
    v_max_f32_dpp v165, v165, v165 quad_perm:[2,3,0,1] row_mask:0xf bank_mask:0xf
    s_nop 1
    v_max_f32_dpp v165, v165, v165 row_half_mirror row_mask:0xf bank_mask:0xf
    s_nop 1
    v_max_f32_dpp v165, v165, v165 row_mirror row_mask:0xf bank_mask:0xf
    v_mov_b32 v160, v165
    s_nop 1
    v_permlane32_swap_b32 v165, v160
    v_max_f32 v165, v165, v160
    v_mul_f32 v165, s86, v165
    v_fma_f32 v56, v164, s86, -v165
    v_exp_f32 v56, v56
    ds_write_b32 v6, v165 offset:3072
    ds_write_b32 v5, v56 offset:1024
    ds_read_b128 v[8:11], v4 offset:1024
    ds_read_b128 v[12:15], v4 offset:1040
    ds_read_b128 v[16:19], v4 offset:1056
    ds_read_b128 v[20:23], v4 offset:1072
    ds_read_b128 v[24:27], v4 offset:1088
    ds_read_b128 v[28:31], v4 offset:1104
    ds_read_b128 v[32:35], v4 offset:1120
    ds_read_b128 v[36:39], v4 offset:1136
    v_add_f32_dpp v56, v56, v56 quad_perm:[1,0,3,2] row_mask:0xf bank_mask:0xf
    s_nop 1
    v_add_f32_dpp v56, v56, v56 quad_perm:[2,3,0,1] row_mask:0xf bank_mask:0xf
    s_nop 1
    v_add_f32_dpp v56, v56, v56 row_half_mirror row_mask:0xf bank_mask:0xf
    s_nop 1
    v_add_f32_dpp v56, v56, v56 row_mirror row_mask:0xf bank_mask:0xf
    v_mov_b32 v160, v56
    s_nop 1
    v_permlane32_swap_b32 v56, v160
    v_add_f32 v56, v56, v160
    s_waitcnt lgkmcnt(0)
    v_lshrrev_b32 v7, 2, v1
    v_and_b32 v65, 3, v1
    v_lshlrev_b32 v65, 4, v65
    v_mul_u32_u24 v64, 896, v7
    v_add_u32 v64, v64, v65
    s_mul_i32 s94, s75, 229376
    s_lshl_b32 s79, s76, 6
    s_add_u32 s94, s94, s79
    s_mul_i32 s79, s3, 28672
    s_add_u32 s94, s94, s79
    s_lshl_b32 s95, s3, 11
    s_add_u32 s95, s95, 13312
    s_mov_b32 s88, 14336
    s_cmp_eq_u32 s100, 0
    s_cbranch_scc1 L_dsetup
    v_lshrrev_b32 v7, 3, v1
    v_and_b32 v65, 7, v1
    v_lshlrev_b32 v65, 4, v65
    v_mul_u32_u24 v64, 3584, v7
    v_add_u32 v64, v64, v65
    s_lshl_b32 s94, s77, 7
    s_mul_i32 s79, s3, 200704
    s_add_u32 s94, s94, s79
    s_mul_i32 s95, s3, 7168
    s_add_u32 s95, s95, 13312
    s_mov_b32 s88, 28672
    s_mov_b32 s44, s48
    s_mov_b32 s45, s49
    s_mov_b32 s46, s50
L_dsetup:
    s_nop 4
    s_lshr_b32 s90, s3, 2
    v_lshlrev_b32 v7, 3, v0
    buffer_load_dwordx2 v[136:137], v7, s[56:59], 0 offen
    s_cmp_lg_u32 s100, 0
    s_cbranch_scc1 L_vphaseC
    buffer_load_dwordx4 v[84:87], v2, s[32:35], s68 offen offset:3072 nt
    s_mov_b32 m0, s95
    s_nop 0
    buffer_load_dwordx4 v64, s[44:47], s94 offen nt lds
    s_add_u32 s94, s94, s88
    s_add_u32 s95, s95, 1024
    buffer_load_dwordx4 v[88:91], v2, s[32:35], s69 offen offset:0 nt
    s_barrier
    v_mov_b32 v7, 0
    ds_read_b128 v[40:43], v7 offset:3072
    ds_read_b128 v[44:47], v7 offset:3088
    ds_read_b128 v[48:51], v7 offset:3104
    ds_read_b128 v[52:55], v7 offset:3120
    s_lshl_b32 s78, s3, 2
    v_mov_b32 v7, s78
    ds_read_b32 v58, v7 offset:3072
    ds_read_b32 v59, v7 offset:3104
    s_waitcnt lgkmcnt(0)
    v_max3_f32 v66, v40, v41, v42
    v_max3_f32 v66, v66, v43, v44
    v_max3_f32 v66, v66, v45, v46
    v_max_f32 v60, v66, v47
    v_max3_f32 v67, v48, v49, v50
    v_max3_f32 v67, v67, v51, v52
    v_max3_f32 v67, v67, v53, v54
    v_max_f32 v61, v67, v55
    v_sub_f32 v58, v58, v60
    v_sub_f32 v59, v59, v61
    v_exp_f32 v58, v58
    v_exp_f32 v59, v59
    v_bfe_u32 v7, v1, 4, 1
    v_cmp_eq_u32 vcc, 1, v7
    s_nop 1
    v_cndmask_b32 v66, v58, v59, vcc
    v_mul_f32 v66, v66, v56
    ds_write_b32 v6, v66 offset:3136
    s_mov_b32 m0, s95
    s_nop 0
    buffer_load_dwordx4 v64, s[44:47], s94 offen nt lds
    s_add_u32 s94, s94, s88
    s_add_u32 s95, s95, 1024
    s_waitcnt vmcnt(6)
    buffer_load_dwordx4 v[92:95], v2, s[32:35], s69 offen offset:1024 nt
    v_lshlrev_b32 v160, 16, v72
    v_and_b32 v161, 0xffff0000, v72
    v_pk_fma_f32 v[144:145], v[160:161], v[8:9], v[144:145] op_sel:[0,0,0] op_sel_hi:[1,0,1]
    v_pk_fma_f32 v[152:153], v[160:161], v[8:9], v[152:153] op_sel:[0,1,0] op_sel_hi:[1,1,1]
    v_lshlrev_b32 v162, 16, v73
    v_and_b32 v163, 0xffff0000, v73
    v_pk_fma_f32 v[146:147], v[162:163], v[8:9], v[146:147] op_sel:[0,0,0] op_sel_hi:[1,0,1]
    v_pk_fma_f32 v[154:155], v[162:163], v[8:9], v[154:155] op_sel:[0,1,0] op_sel_hi:[1,1,1]
    v_lshlrev_b32 v160, 16, v74
    v_and_b32 v161, 0xffff0000, v74
    v_pk_fma_f32 v[148:149], v[160:161], v[8:9], v[148:149] op_sel:[0,0,0] op_sel_hi:[1,0,1]
    v_pk_fma_f32 v[156:157], v[160:161], v[8:9], v[156:157] op_sel:[0,1,0] op_sel_hi:[1,1,1]
    v_lshlrev_b32 v162, 16, v75
    v_and_b32 v163, 0xffff0000, v75
    v_pk_fma_f32 v[150:151], v[162:163], v[8:9], v[150:151] op_sel:[0,0,0] op_sel_hi:[1,0,1]
    v_pk_fma_f32 v[158:159], v[162:163], v[8:9], v[158:159] op_sel:[0,1,0] op_sel_hi:[1,1,1]
    v_lshlrev_b32 v160, 16, v76
    v_and_b32 v161, 0xffff0000, v76
    v_pk_fma_f32 v[144:145], v[160:161], v[10:11], v[144:145] op_sel:[0,0,0] op_sel_hi:[1,0,1]
    v_pk_fma_f32 v[152:153], v[160:161], v[10:11], v[152:153] op_sel:[0,1,0] op_sel_hi:[1,1,1]
    v_lshlrev_b32 v162, 16, v77
    v_and_b32 v163, 0xffff0000, v77
    v_pk_fma_f32 v[146:147], v[162:163], v[10:11], v[146:147] op_sel:[0,0,0] op_sel_hi:[1,0,1]
    v_pk_fma_f32 v[154:155], v[162:163], v[10:11], v[154:155] op_sel:[0,1,0] op_sel_hi:[1,1,1]
    v_lshlrev_b32 v160, 16, v78
    v_and_b32 v161, 0xffff0000, v78
    v_pk_fma_f32 v[148:149], v[160:161], v[10:11], v[148:149] op_sel:[0,0,0] op_sel_hi:[1,0,1]
    v_pk_fma_f32 v[156:157], v[160:161], v[10:11], v[156:157] op_sel:[0,1,0] op_sel_hi:[1,1,1]
    v_lshlrev_b32 v162, 16, v79
    v_and_b32 v163, 0xffff0000, v79
    v_pk_fma_f32 v[150:151], v[162:163], v[10:11], v[150:151] op_sel:[0,0,0] op_sel_hi:[1,0,1]
    v_pk_fma_f32 v[158:159], v[162:163], v[10:11], v[158:159] op_sel:[0,1,0] op_sel_hi:[1,1,1]
    s_waitcnt vmcnt(6)
    buffer_load_dwordx4 v[96:99], v2, s[32:35], s69 offen offset:2048 nt
    v_lshlrev_b32 v160, 16, v80
    v_and_b32 v161, 0xffff0000, v80
    v_pk_fma_f32 v[144:145], v[160:161], v[12:13], v[144:145] op_sel:[0,0,0] op_sel_hi:[1,0,1]
    v_pk_fma_f32 v[152:153], v[160:161], v[12:13], v[152:153] op_sel:[0,1,0] op_sel_hi:[1,1,1]
    v_lshlrev_b32 v162, 16, v81
    v_and_b32 v163, 0xffff0000, v81
    v_pk_fma_f32 v[146:147], v[162:163], v[12:13], v[146:147] op_sel:[0,0,0] op_sel_hi:[1,0,1]
    v_pk_fma_f32 v[154:155], v[162:163], v[12:13], v[154:155] op_sel:[0,1,0] op_sel_hi:[1,1,1]
    v_lshlrev_b32 v160, 16, v82
    v_and_b32 v161, 0xffff0000, v82
    v_pk_fma_f32 v[148:149], v[160:161], v[12:13], v[148:149] op_sel:[0,0,0] op_sel_hi:[1,0,1]
    v_pk_fma_f32 v[156:157], v[160:161], v[12:13], v[156:157] op_sel:[0,1,0] op_sel_hi:[1,1,1]
    v_lshlrev_b32 v162, 16, v83
    v_and_b32 v163, 0xffff0000, v83
    v_pk_fma_f32 v[150:151], v[162:163], v[12:13], v[150:151] op_sel:[0,0,0] op_sel_hi:[1,0,1]
    v_pk_fma_f32 v[158:159], v[162:163], v[12:13], v[158:159] op_sel:[0,1,0] op_sel_hi:[1,1,1]
    s_waitcnt vmcnt(6)
    buffer_load_dwordx4 v[100:103], v2, s[32:35], s69 offen offset:3072 nt
    s_waitcnt vmcnt(6)
    buffer_load_dwordx4 v[104:107], v2, s[32:35], s70 offen offset:0 nt
    v_lshlrev_b32 v160, 16, v84
    v_and_b32 v161, 0xffff0000, v84
    v_pk_fma_f32 v[144:145], v[160:161], v[14:15], v[144:145] op_sel:[0,0,0] op_sel_hi:[1,0,1]
    v_pk_fma_f32 v[152:153], v[160:161], v[14:15], v[152:153] op_sel:[0,1,0] op_sel_hi:[1,1,1]
    v_lshlrev_b32 v162, 16, v85
    v_and_b32 v163, 0xffff0000, v85
    v_pk_fma_f32 v[146:147], v[162:163], v[14:15], v[146:147] op_sel:[0,0,0] op_sel_hi:[1,0,1]
    v_pk_fma_f32 v[154:155], v[162:163], v[14:15], v[154:155] op_sel:[0,1,0] op_sel_hi:[1,1,1]
    v_lshlrev_b32 v160, 16, v86
    v_and_b32 v161, 0xffff0000, v86
    v_pk_fma_f32 v[148:149], v[160:161], v[14:15], v[148:149] op_sel:[0,0,0] op_sel_hi:[1,0,1]
    v_pk_fma_f32 v[156:157], v[160:161], v[14:15], v[156:157] op_sel:[0,1,0] op_sel_hi:[1,1,1]
    v_lshlrev_b32 v162, 16, v87
    v_and_b32 v163, 0xffff0000, v87
    v_pk_fma_f32 v[150:151], v[162:163], v[14:15], v[150:151] op_sel:[0,0,0] op_sel_hi:[1,0,1]
    v_pk_fma_f32 v[158:159], v[162:163], v[14:15], v[158:159] op_sel:[0,1,0] op_sel_hi:[1,1,1]
    s_waitcnt vmcnt(6)
    buffer_load_dwordx4 v[108:111], v2, s[32:35], s70 offen offset:1024 nt
    s_waitcnt vmcnt(6)
    buffer_load_dwordx4 v[112:115], v2, s[32:35], s70 offen offset:2048 nt
    v_lshlrev_b32 v160, 16, v88
    v_and_b32 v161, 0xffff0000, v88
    v_pk_fma_f32 v[144:145], v[160:161], v[16:17], v[144:145] op_sel:[0,0,0] op_sel_hi:[1,0,1]
    v_pk_fma_f32 v[152:153], v[160:161], v[16:17], v[152:153] op_sel:[0,1,0] op_sel_hi:[1,1,1]
    v_lshlrev_b32 v162, 16, v89
    v_and_b32 v163, 0xffff0000, v89
    v_pk_fma_f32 v[146:147], v[162:163], v[16:17], v[146:147] op_sel:[0,0,0] op_sel_hi:[1,0,1]
    v_pk_fma_f32 v[154:155], v[162:163], v[16:17], v[154:155] op_sel:[0,1,0] op_sel_hi:[1,1,1]
    v_lshlrev_b32 v160, 16, v90
    v_and_b32 v161, 0xffff0000, v90
    v_pk_fma_f32 v[148:149], v[160:161], v[16:17], v[148:149] op_sel:[0,0,0] op_sel_hi:[1,0,1]
    v_pk_fma_f32 v[156:157], v[160:161], v[16:17], v[156:157] op_sel:[0,1,0] op_sel_hi:[1,1,1]
    v_lshlrev_b32 v162, 16, v91
    v_and_b32 v163, 0xffff0000, v91
    v_pk_fma_f32 v[150:151], v[162:163], v[16:17], v[150:151] op_sel:[0,0,0] op_sel_hi:[1,0,1]
    v_pk_fma_f32 v[158:159], v[162:163], v[16:17], v[158:159] op_sel:[0,1,0] op_sel_hi:[1,1,1]
    s_waitcnt vmcnt(6)
    buffer_load_dwordx4 v[116:119], v2, s[32:35], s70 offen offset:3072 nt
    s_waitcnt vmcnt(6)
    buffer_load_dwordx4 v[120:123], v2, s[32:35], s71 offen offset:0 nt
    v_lshlrev_b32 v160, 16, v92
    v_and_b32 v161, 0xffff0000, v92
    v_pk_fma_f32 v[144:145], v[160:161], v[18:19], v[144:145] op_sel:[0,0,0] op_sel_hi:[1,0,1]
    v_pk_fma_f32 v[152:153], v[160:161], v[18:19], v[152:153] op_sel:[0,1,0] op_sel_hi:[1,1,1]
    v_lshlrev_b32 v162, 16, v93
    v_and_b32 v163, 0xffff0000, v93
    v_pk_fma_f32 v[146:147], v[162:163], v[18:19], v[146:147] op_sel:[0,0,0] op_sel_hi:[1,0,1]
    v_pk_fma_f32 v[154:155], v[162:163], v[18:19], v[154:155] op_sel:[0,1,0] op_sel_hi:[1,1,1]
    v_lshlrev_b32 v160, 16, v94
    v_and_b32 v161, 0xffff0000, v94
    v_pk_fma_f32 v[148:149], v[160:161], v[18:19], v[148:149] op_sel:[0,0,0] op_sel_hi:[1,0,1]
    v_pk_fma_f32 v[156:157], v[160:161], v[18:19], v[156:157] op_sel:[0,1,0] op_sel_hi:[1,1,1]
    v_lshlrev_b32 v162, 16, v95
    v_and_b32 v163, 0xffff0000, v95
    v_pk_fma_f32 v[150:151], v[162:163], v[18:19], v[150:151] op_sel:[0,0,0] op_sel_hi:[1,0,1]
    v_pk_fma_f32 v[158:159], v[162:163], v[18:19], v[158:159] op_sel:[0,1,0] op_sel_hi:[1,1,1]
    s_waitcnt vmcnt(6)
    buffer_load_dwordx4 v[124:127], v2, s[32:35], s71 offen offset:1024 nt
    v_lshlrev_b32 v160, 16, v96
    v_and_b32 v161, 0xffff0000, v96
    v_pk_fma_f32 v[144:145], v[160:161], v[20:21], v[144:145] op_sel:[0,0,0] op_sel_hi:[1,0,1]
    v_pk_fma_f32 v[152:153], v[160:161], v[20:21], v[152:153] op_sel:[0,1,0] op_sel_hi:[1,1,1]
    v_lshlrev_b32 v162, 16, v97
    v_and_b32 v163, 0xffff0000, v97
    v_pk_fma_f32 v[146:147], v[162:163], v[20:21], v[146:147] op_sel:[0,0,0] op_sel_hi:[1,0,1]
    v_pk_fma_f32 v[154:155], v[162:163], v[20:21], v[154:155] op_sel:[0,1,0] op_sel_hi:[1,1,1]
    v_lshlrev_b32 v160, 16, v98
    v_and_b32 v161, 0xffff0000, v98
    v_pk_fma_f32 v[148:149], v[160:161], v[20:21], v[148:149] op_sel:[0,0,0] op_sel_hi:[1,0,1]
    v_pk_fma_f32 v[156:157], v[160:161], v[20:21], v[156:157] op_sel:[0,1,0] op_sel_hi:[1,1,1]
    v_lshlrev_b32 v162, 16, v99
    v_and_b32 v163, 0xffff0000, v99
    v_pk_fma_f32 v[150:151], v[162:163], v[20:21], v[150:151] op_sel:[0,0,0] op_sel_hi:[1,0,1]
    v_pk_fma_f32 v[158:159], v[162:163], v[20:21], v[158:159] op_sel:[0,1,0] op_sel_hi:[1,1,1]
    s_waitcnt vmcnt(6)
    buffer_load_dwordx4 v[128:131], v2, s[32:35], s71 offen offset:2048 nt
    v_lshlrev_b32 v160, 16, v100
    v_and_b32 v161, 0xffff0000, v100
    v_pk_fma_f32 v[144:145], v[160:161], v[22:23], v[144:145] op_sel:[0,0,0] op_sel_hi:[1,0,1]
    v_pk_fma_f32 v[152:153], v[160:161], v[22:23], v[152:153] op_sel:[0,1,0] op_sel_hi:[1,1,1]
    v_lshlrev_b32 v162, 16, v101
    v_and_b32 v163, 0xffff0000, v101
    v_pk_fma_f32 v[146:147], v[162:163], v[22:23], v[146:147] op_sel:[0,0,0] op_sel_hi:[1,0,1]
    v_pk_fma_f32 v[154:155], v[162:163], v[22:23], v[154:155] op_sel:[0,1,0] op_sel_hi:[1,1,1]
    v_lshlrev_b32 v160, 16, v102
    v_and_b32 v161, 0xffff0000, v102
    v_pk_fma_f32 v[148:149], v[160:161], v[22:23], v[148:149] op_sel:[0,0,0] op_sel_hi:[1,0,1]
    v_pk_fma_f32 v[156:157], v[160:161], v[22:23], v[156:157] op_sel:[0,1,0] op_sel_hi:[1,1,1]
    v_lshlrev_b32 v162, 16, v103
    v_and_b32 v163, 0xffff0000, v103
    v_pk_fma_f32 v[150:151], v[162:163], v[22:23], v[150:151] op_sel:[0,0,0] op_sel_hi:[1,0,1]
    v_pk_fma_f32 v[158:159], v[162:163], v[22:23], v[158:159] op_sel:[0,1,0] op_sel_hi:[1,1,1]
    s_waitcnt vmcnt(6)
    buffer_load_dwordx4 v[132:135], v2, s[32:35], s71 offen offset:3072 nt
    v_lshlrev_b32 v160, 16, v104
    v_and_b32 v161, 0xffff0000, v104
    v_pk_fma_f32 v[144:145], v[160:161], v[24:25], v[144:145] op_sel:[0,0,0] op_sel_hi:[1,0,1]
    v_pk_fma_f32 v[152:153], v[160:161], v[24:25], v[152:153] op_sel:[0,1,0] op_sel_hi:[1,1,1]
    v_lshlrev_b32 v162, 16, v105
    v_and_b32 v163, 0xffff0000, v105
    v_pk_fma_f32 v[146:147], v[162:163], v[24:25], v[146:147] op_sel:[0,0,0] op_sel_hi:[1,0,1]
    v_pk_fma_f32 v[154:155], v[162:163], v[24:25], v[154:155] op_sel:[0,1,0] op_sel_hi:[1,1,1]
    v_lshlrev_b32 v160, 16, v106
    v_and_b32 v161, 0xffff0000, v106
    v_pk_fma_f32 v[148:149], v[160:161], v[24:25], v[148:149] op_sel:[0,0,0] op_sel_hi:[1,0,1]
    v_pk_fma_f32 v[156:157], v[160:161], v[24:25], v[156:157] op_sel:[0,1,0] op_sel_hi:[1,1,1]
    v_lshlrev_b32 v162, 16, v107
    v_and_b32 v163, 0xffff0000, v107
    v_pk_fma_f32 v[150:151], v[162:163], v[24:25], v[150:151] op_sel:[0,0,0] op_sel_hi:[1,0,1]
    v_pk_fma_f32 v[158:159], v[162:163], v[24:25], v[158:159] op_sel:[0,1,0] op_sel_hi:[1,1,1]
    s_waitcnt vmcnt(6)
    v_lshlrev_b32 v160, 16, v108
    v_and_b32 v161, 0xffff0000, v108
    v_pk_fma_f32 v[144:145], v[160:161], v[26:27], v[144:145] op_sel:[0,0,0] op_sel_hi:[1,0,1]
    v_pk_fma_f32 v[152:153], v[160:161], v[26:27], v[152:153] op_sel:[0,1,0] op_sel_hi:[1,1,1]
    v_lshlrev_b32 v162, 16, v109
    v_and_b32 v163, 0xffff0000, v109
    v_pk_fma_f32 v[146:147], v[162:163], v[26:27], v[146:147] op_sel:[0,0,0] op_sel_hi:[1,0,1]
    v_pk_fma_f32 v[154:155], v[162:163], v[26:27], v[154:155] op_sel:[0,1,0] op_sel_hi:[1,1,1]
    v_lshlrev_b32 v160, 16, v110
    v_and_b32 v161, 0xffff0000, v110
    v_pk_fma_f32 v[148:149], v[160:161], v[26:27], v[148:149] op_sel:[0,0,0] op_sel_hi:[1,0,1]
    v_pk_fma_f32 v[156:157], v[160:161], v[26:27], v[156:157] op_sel:[0,1,0] op_sel_hi:[1,1,1]
    v_lshlrev_b32 v162, 16, v111
    v_and_b32 v163, 0xffff0000, v111
    v_pk_fma_f32 v[150:151], v[162:163], v[26:27], v[150:151] op_sel:[0,0,0] op_sel_hi:[1,0,1]
    v_pk_fma_f32 v[158:159], v[162:163], v[26:27], v[158:159] op_sel:[0,1,0] op_sel_hi:[1,1,1]
    s_waitcnt vmcnt(5)
    v_lshlrev_b32 v160, 16, v112
    v_and_b32 v161, 0xffff0000, v112
    v_pk_fma_f32 v[144:145], v[160:161], v[28:29], v[144:145] op_sel:[0,0,0] op_sel_hi:[1,0,1]
    v_pk_fma_f32 v[152:153], v[160:161], v[28:29], v[152:153] op_sel:[0,1,0] op_sel_hi:[1,1,1]
    v_lshlrev_b32 v162, 16, v113
    v_and_b32 v163, 0xffff0000, v113
    v_pk_fma_f32 v[146:147], v[162:163], v[28:29], v[146:147] op_sel:[0,0,0] op_sel_hi:[1,0,1]
    v_pk_fma_f32 v[154:155], v[162:163], v[28:29], v[154:155] op_sel:[0,1,0] op_sel_hi:[1,1,1]
    v_lshlrev_b32 v160, 16, v114
    v_and_b32 v161, 0xffff0000, v114
    v_pk_fma_f32 v[148:149], v[160:161], v[28:29], v[148:149] op_sel:[0,0,0] op_sel_hi:[1,0,1]
    v_pk_fma_f32 v[156:157], v[160:161], v[28:29], v[156:157] op_sel:[0,1,0] op_sel_hi:[1,1,1]
    v_lshlrev_b32 v162, 16, v115
    v_and_b32 v163, 0xffff0000, v115
    v_pk_fma_f32 v[150:151], v[162:163], v[28:29], v[150:151] op_sel:[0,0,0] op_sel_hi:[1,0,1]
    v_pk_fma_f32 v[158:159], v[162:163], v[28:29], v[158:159] op_sel:[0,1,0] op_sel_hi:[1,1,1]
    s_waitcnt vmcnt(4)
    v_lshlrev_b32 v160, 16, v116
    v_and_b32 v161, 0xffff0000, v116
    v_pk_fma_f32 v[144:145], v[160:161], v[30:31], v[144:145] op_sel:[0,0,0] op_sel_hi:[1,0,1]
    v_pk_fma_f32 v[152:153], v[160:161], v[30:31], v[152:153] op_sel:[0,1,0] op_sel_hi:[1,1,1]
    v_lshlrev_b32 v162, 16, v117
    v_and_b32 v163, 0xffff0000, v117
    v_pk_fma_f32 v[146:147], v[162:163], v[30:31], v[146:147] op_sel:[0,0,0] op_sel_hi:[1,0,1]
    v_pk_fma_f32 v[154:155], v[162:163], v[30:31], v[154:155] op_sel:[0,1,0] op_sel_hi:[1,1,1]
    v_lshlrev_b32 v160, 16, v118
    v_and_b32 v161, 0xffff0000, v118
    v_pk_fma_f32 v[148:149], v[160:161], v[30:31], v[148:149] op_sel:[0,0,0] op_sel_hi:[1,0,1]
    v_pk_fma_f32 v[156:157], v[160:161], v[30:31], v[156:157] op_sel:[0,1,0] op_sel_hi:[1,1,1]
    v_lshlrev_b32 v162, 16, v119
    v_and_b32 v163, 0xffff0000, v119
    v_pk_fma_f32 v[150:151], v[162:163], v[30:31], v[150:151] op_sel:[0,0,0] op_sel_hi:[1,0,1]
    v_pk_fma_f32 v[158:159], v[162:163], v[30:31], v[158:159] op_sel:[0,1,0] op_sel_hi:[1,1,1]
    s_waitcnt vmcnt(3)
    v_lshlrev_b32 v160, 16, v120
    v_and_b32 v161, 0xffff0000, v120
    v_pk_fma_f32 v[144:145], v[160:161], v[32:33], v[144:145] op_sel:[0,0,0] op_sel_hi:[1,0,1]
    v_pk_fma_f32 v[152:153], v[160:161], v[32:33], v[152:153] op_sel:[0,1,0] op_sel_hi:[1,1,1]
    v_lshlrev_b32 v162, 16, v121
    v_and_b32 v163, 0xffff0000, v121
    v_pk_fma_f32 v[146:147], v[162:163], v[32:33], v[146:147] op_sel:[0,0,0] op_sel_hi:[1,0,1]
    v_pk_fma_f32 v[154:155], v[162:163], v[32:33], v[154:155] op_sel:[0,1,0] op_sel_hi:[1,1,1]
    v_lshlrev_b32 v160, 16, v122
    v_and_b32 v161, 0xffff0000, v122
    v_pk_fma_f32 v[148:149], v[160:161], v[32:33], v[148:149] op_sel:[0,0,0] op_sel_hi:[1,0,1]
    v_pk_fma_f32 v[156:157], v[160:161], v[32:33], v[156:157] op_sel:[0,1,0] op_sel_hi:[1,1,1]
    v_lshlrev_b32 v162, 16, v123
    v_and_b32 v163, 0xffff0000, v123
    v_pk_fma_f32 v[150:151], v[162:163], v[32:33], v[150:151] op_sel:[0,0,0] op_sel_hi:[1,0,1]
    v_pk_fma_f32 v[158:159], v[162:163], v[32:33], v[158:159] op_sel:[0,1,0] op_sel_hi:[1,1,1]
    s_waitcnt vmcnt(2)
    v_lshlrev_b32 v160, 16, v124
    v_and_b32 v161, 0xffff0000, v124
    v_pk_fma_f32 v[144:145], v[160:161], v[34:35], v[144:145] op_sel:[0,0,0] op_sel_hi:[1,0,1]
    v_pk_fma_f32 v[152:153], v[160:161], v[34:35], v[152:153] op_sel:[0,1,0] op_sel_hi:[1,1,1]
    v_lshlrev_b32 v162, 16, v125
    v_and_b32 v163, 0xffff0000, v125
    v_pk_fma_f32 v[146:147], v[162:163], v[34:35], v[146:147] op_sel:[0,0,0] op_sel_hi:[1,0,1]
    v_pk_fma_f32 v[154:155], v[162:163], v[34:35], v[154:155] op_sel:[0,1,0] op_sel_hi:[1,1,1]
    v_lshlrev_b32 v160, 16, v126
    v_and_b32 v161, 0xffff0000, v126
    v_pk_fma_f32 v[148:149], v[160:161], v[34:35], v[148:149] op_sel:[0,0,0] op_sel_hi:[1,0,1]
    v_pk_fma_f32 v[156:157], v[160:161], v[34:35], v[156:157] op_sel:[0,1,0] op_sel_hi:[1,1,1]
    v_lshlrev_b32 v162, 16, v127
    v_and_b32 v163, 0xffff0000, v127
    v_pk_fma_f32 v[150:151], v[162:163], v[34:35], v[150:151] op_sel:[0,0,0] op_sel_hi:[1,0,1]
    v_pk_fma_f32 v[158:159], v[162:163], v[34:35], v[158:159] op_sel:[0,1,0] op_sel_hi:[1,1,1]
    s_waitcnt vmcnt(1)
    v_lshlrev_b32 v160, 16, v128
    v_and_b32 v161, 0xffff0000, v128
    v_pk_fma_f32 v[144:145], v[160:161], v[36:37], v[144:145] op_sel:[0,0,0] op_sel_hi:[1,0,1]
    v_pk_fma_f32 v[152:153], v[160:161], v[36:37], v[152:153] op_sel:[0,1,0] op_sel_hi:[1,1,1]
    v_lshlrev_b32 v162, 16, v129
    v_and_b32 v163, 0xffff0000, v129
    v_pk_fma_f32 v[146:147], v[162:163], v[36:37], v[146:147] op_sel:[0,0,0] op_sel_hi:[1,0,1]
    v_pk_fma_f32 v[154:155], v[162:163], v[36:37], v[154:155] op_sel:[0,1,0] op_sel_hi:[1,1,1]
    v_lshlrev_b32 v160, 16, v130
    v_and_b32 v161, 0xffff0000, v130
    v_pk_fma_f32 v[148:149], v[160:161], v[36:37], v[148:149] op_sel:[0,0,0] op_sel_hi:[1,0,1]
    v_pk_fma_f32 v[156:157], v[160:161], v[36:37], v[156:157] op_sel:[0,1,0] op_sel_hi:[1,1,1]
    v_lshlrev_b32 v162, 16, v131
    v_and_b32 v163, 0xffff0000, v131
    v_pk_fma_f32 v[150:151], v[162:163], v[36:37], v[150:151] op_sel:[0,0,0] op_sel_hi:[1,0,1]
    v_pk_fma_f32 v[158:159], v[162:163], v[36:37], v[158:159] op_sel:[0,1,0] op_sel_hi:[1,1,1]
    s_waitcnt vmcnt(0)
    v_lshlrev_b32 v160, 16, v132
    v_and_b32 v161, 0xffff0000, v132
    v_pk_fma_f32 v[144:145], v[160:161], v[38:39], v[144:145] op_sel:[0,0,0] op_sel_hi:[1,0,1]
    v_pk_fma_f32 v[152:153], v[160:161], v[38:39], v[152:153] op_sel:[0,1,0] op_sel_hi:[1,1,1]
    v_lshlrev_b32 v162, 16, v133
    v_and_b32 v163, 0xffff0000, v133
    v_pk_fma_f32 v[146:147], v[162:163], v[38:39], v[146:147] op_sel:[0,0,0] op_sel_hi:[1,0,1]
    v_pk_fma_f32 v[154:155], v[162:163], v[38:39], v[154:155] op_sel:[0,1,0] op_sel_hi:[1,1,1]
    v_lshlrev_b32 v160, 16, v134
    v_and_b32 v161, 0xffff0000, v134
    v_pk_fma_f32 v[148:149], v[160:161], v[38:39], v[148:149] op_sel:[0,0,0] op_sel_hi:[1,0,1]
    v_pk_fma_f32 v[156:157], v[160:161], v[38:39], v[156:157] op_sel:[0,1,0] op_sel_hi:[1,1,1]
    v_lshlrev_b32 v162, 16, v135
    v_and_b32 v163, 0xffff0000, v135
    v_pk_fma_f32 v[150:151], v[162:163], v[38:39], v[150:151] op_sel:[0,0,0] op_sel_hi:[1,0,1]
    v_pk_fma_f32 v[158:159], v[162:163], v[38:39], v[158:159] op_sel:[0,1,0] op_sel_hi:[1,1,1]
    s_branch L_vphase_done
L_vphaseC:
    s_nop 4
    buffer_load_dwordx4 v[84:87], v2, s[32:35], s68 offen offset:3072 nt
    s_mov_b32 m0, s95
    s_nop 0
    buffer_load_dwordx4 v64, s[44:47], s94 offen nt lds
    s_add_u32 s94, s94, s88
    s_add_u32 s95, s95, 1024
    buffer_load_dwordx4 v[88:91], v2, s[32:35], s69 offen offset:0 nt
    s_barrier
    v_mov_b32 v7, 0
    ds_read_b128 v[40:43], v7 offset:3072
    ds_read_b128 v[44:47], v7 offset:3088
    ds_read_b128 v[48:51], v7 offset:3104
    ds_read_b128 v[52:55], v7 offset:3120
    s_lshl_b32 s78, s3, 2
    v_mov_b32 v7, s78
    ds_read_b32 v58, v7 offset:3072
    ds_read_b32 v59, v7 offset:3104
    s_waitcnt lgkmcnt(0)
    v_max3_f32 v66, v40, v41, v42
    v_max3_f32 v66, v66, v43, v44
    v_max3_f32 v66, v66, v45, v46
    v_max_f32 v60, v66, v47
    v_max3_f32 v67, v48, v49, v50
    v_max3_f32 v67, v67, v51, v52
    v_max3_f32 v67, v67, v53, v54
    v_max_f32 v61, v67, v55
    v_sub_f32 v58, v58, v60
    v_sub_f32 v59, v59, v61
    v_exp_f32 v58, v58
    v_exp_f32 v59, v59
    v_bfe_u32 v7, v1, 4, 1
    v_cmp_eq_u32 vcc, 1, v7
    s_nop 1
    v_cndmask_b32 v66, v58, v59, vcc
    v_mul_f32 v66, v66, v56
    ds_write_b32 v6, v66 offset:3136
    s_mov_b32 m0, s95
    s_nop 0
    buffer_load_dwordx4 v64, s[44:47], s94 offen nt lds
    s_add_u32 s94, s94, s88
    s_add_u32 s95, s95, 1024
    s_waitcnt vmcnt(6)
    buffer_load_dwordx4 v[92:95], v2, s[32:35], s69 offen offset:1024 nt
    s_mov_b32 m0, s95
    s_nop 0
    buffer_load_dwordx4 v64, s[44:47], s94 offen nt lds
    s_add_u32 s94, s94, s88
    s_add_u32 s95, s95, 1024
    v_lshlrev_b32 v160, 16, v72
    v_and_b32 v161, 0xffff0000, v72
    v_pk_fma_f32 v[144:145], v[160:161], v[8:9], v[144:145] op_sel:[0,0,0] op_sel_hi:[1,0,1]
    v_pk_fma_f32 v[152:153], v[160:161], v[8:9], v[152:153] op_sel:[0,1,0] op_sel_hi:[1,1,1]
    v_lshlrev_b32 v162, 16, v73
    v_and_b32 v163, 0xffff0000, v73
    v_pk_fma_f32 v[146:147], v[162:163], v[8:9], v[146:147] op_sel:[0,0,0] op_sel_hi:[1,0,1]
    v_pk_fma_f32 v[154:155], v[162:163], v[8:9], v[154:155] op_sel:[0,1,0] op_sel_hi:[1,1,1]
    v_lshlrev_b32 v160, 16, v74
    v_and_b32 v161, 0xffff0000, v74
    v_pk_fma_f32 v[148:149], v[160:161], v[8:9], v[148:149] op_sel:[0,0,0] op_sel_hi:[1,0,1]
    v_pk_fma_f32 v[156:157], v[160:161], v[8:9], v[156:157] op_sel:[0,1,0] op_sel_hi:[1,1,1]
    v_lshlrev_b32 v162, 16, v75
    v_and_b32 v163, 0xffff0000, v75
    v_pk_fma_f32 v[150:151], v[162:163], v[8:9], v[150:151] op_sel:[0,0,0] op_sel_hi:[1,0,1]
    v_pk_fma_f32 v[158:159], v[162:163], v[8:9], v[158:159] op_sel:[0,1,0] op_sel_hi:[1,1,1]
    v_lshlrev_b32 v160, 16, v76
    v_and_b32 v161, 0xffff0000, v76
    v_pk_fma_f32 v[144:145], v[160:161], v[10:11], v[144:145] op_sel:[0,0,0] op_sel_hi:[1,0,1]
    v_pk_fma_f32 v[152:153], v[160:161], v[10:11], v[152:153] op_sel:[0,1,0] op_sel_hi:[1,1,1]
    v_lshlrev_b32 v162, 16, v77
    v_and_b32 v163, 0xffff0000, v77
    v_pk_fma_f32 v[146:147], v[162:163], v[10:11], v[146:147] op_sel:[0,0,0] op_sel_hi:[1,0,1]
    v_pk_fma_f32 v[154:155], v[162:163], v[10:11], v[154:155] op_sel:[0,1,0] op_sel_hi:[1,1,1]
    v_lshlrev_b32 v160, 16, v78
    v_and_b32 v161, 0xffff0000, v78
    v_pk_fma_f32 v[148:149], v[160:161], v[10:11], v[148:149] op_sel:[0,0,0] op_sel_hi:[1,0,1]
    v_pk_fma_f32 v[156:157], v[160:161], v[10:11], v[156:157] op_sel:[0,1,0] op_sel_hi:[1,1,1]
    v_lshlrev_b32 v162, 16, v79
    v_and_b32 v163, 0xffff0000, v79
    v_pk_fma_f32 v[150:151], v[162:163], v[10:11], v[150:151] op_sel:[0,0,0] op_sel_hi:[1,0,1]
    v_pk_fma_f32 v[158:159], v[162:163], v[10:11], v[158:159] op_sel:[0,1,0] op_sel_hi:[1,1,1]
    s_waitcnt vmcnt(6)
    buffer_load_dwordx4 v[96:99], v2, s[32:35], s69 offen offset:2048 nt
    s_mov_b32 m0, s95
    s_nop 0
    buffer_load_dwordx4 v64, s[44:47], s94 offen nt lds
    s_add_u32 s94, s94, s88
    s_add_u32 s95, s95, 1024
    v_lshlrev_b32 v160, 16, v80
    v_and_b32 v161, 0xffff0000, v80
    v_pk_fma_f32 v[144:145], v[160:161], v[12:13], v[144:145] op_sel:[0,0,0] op_sel_hi:[1,0,1]
    v_pk_fma_f32 v[152:153], v[160:161], v[12:13], v[152:153] op_sel:[0,1,0] op_sel_hi:[1,1,1]
    v_lshlrev_b32 v162, 16, v81
    v_and_b32 v163, 0xffff0000, v81
    v_pk_fma_f32 v[146:147], v[162:163], v[12:13], v[146:147] op_sel:[0,0,0] op_sel_hi:[1,0,1]
    v_pk_fma_f32 v[154:155], v[162:163], v[12:13], v[154:155] op_sel:[0,1,0] op_sel_hi:[1,1,1]
    v_lshlrev_b32 v160, 16, v82
    v_and_b32 v161, 0xffff0000, v82
    v_pk_fma_f32 v[148:149], v[160:161], v[12:13], v[148:149] op_sel:[0,0,0] op_sel_hi:[1,0,1]
    v_pk_fma_f32 v[156:157], v[160:161], v[12:13], v[156:157] op_sel:[0,1,0] op_sel_hi:[1,1,1]
    v_lshlrev_b32 v162, 16, v83
    v_and_b32 v163, 0xffff0000, v83
    v_pk_fma_f32 v[150:151], v[162:163], v[12:13], v[150:151] op_sel:[0,0,0] op_sel_hi:[1,0,1]
    v_pk_fma_f32 v[158:159], v[162:163], v[12:13], v[158:159] op_sel:[0,1,0] op_sel_hi:[1,1,1]
    s_waitcnt vmcnt(6)
    buffer_load_dwordx4 v[100:103], v2, s[32:35], s69 offen offset:3072 nt
    v_lshlrev_b32 v160, 16, v84
    v_and_b32 v161, 0xffff0000, v84
    v_pk_fma_f32 v[144:145], v[160:161], v[14:15], v[144:145] op_sel:[0,0,0] op_sel_hi:[1,0,1]
    v_pk_fma_f32 v[152:153], v[160:161], v[14:15], v[152:153] op_sel:[0,1,0] op_sel_hi:[1,1,1]
    v_lshlrev_b32 v162, 16, v85
    v_and_b32 v163, 0xffff0000, v85
    v_pk_fma_f32 v[146:147], v[162:163], v[14:15], v[146:147] op_sel:[0,0,0] op_sel_hi:[1,0,1]
    v_pk_fma_f32 v[154:155], v[162:163], v[14:15], v[154:155] op_sel:[0,1,0] op_sel_hi:[1,1,1]
    v_lshlrev_b32 v160, 16, v86
    v_and_b32 v161, 0xffff0000, v86
    v_pk_fma_f32 v[148:149], v[160:161], v[14:15], v[148:149] op_sel:[0,0,0] op_sel_hi:[1,0,1]
    v_pk_fma_f32 v[156:157], v[160:161], v[14:15], v[156:157] op_sel:[0,1,0] op_sel_hi:[1,1,1]
    v_lshlrev_b32 v162, 16, v87
    v_and_b32 v163, 0xffff0000, v87
    v_pk_fma_f32 v[150:151], v[162:163], v[14:15], v[150:151] op_sel:[0,0,0] op_sel_hi:[1,0,1]
    v_pk_fma_f32 v[158:159], v[162:163], v[14:15], v[158:159] op_sel:[0,1,0] op_sel_hi:[1,1,1]
    s_waitcnt vmcnt(6)
    buffer_load_dwordx4 v[104:107], v2, s[32:35], s70 offen offset:0 nt
    v_lshlrev_b32 v160, 16, v88
    v_and_b32 v161, 0xffff0000, v88
    v_pk_fma_f32 v[144:145], v[160:161], v[16:17], v[144:145] op_sel:[0,0,0] op_sel_hi:[1,0,1]
    v_pk_fma_f32 v[152:153], v[160:161], v[16:17], v[152:153] op_sel:[0,1,0] op_sel_hi:[1,1,1]
    v_lshlrev_b32 v162, 16, v89
    v_and_b32 v163, 0xffff0000, v89
    v_pk_fma_f32 v[146:147], v[162:163], v[16:17], v[146:147] op_sel:[0,0,0] op_sel_hi:[1,0,1]
    v_pk_fma_f32 v[154:155], v[162:163], v[16:17], v[154:155] op_sel:[0,1,0] op_sel_hi:[1,1,1]
    v_lshlrev_b32 v160, 16, v90
    v_and_b32 v161, 0xffff0000, v90
    v_pk_fma_f32 v[148:149], v[160:161], v[16:17], v[148:149] op_sel:[0,0,0] op_sel_hi:[1,0,1]
    v_pk_fma_f32 v[156:157], v[160:161], v[16:17], v[156:157] op_sel:[0,1,0] op_sel_hi:[1,1,1]
    v_lshlrev_b32 v162, 16, v91
    v_and_b32 v163, 0xffff0000, v91
    v_pk_fma_f32 v[150:151], v[162:163], v[16:17], v[150:151] op_sel:[0,0,0] op_sel_hi:[1,0,1]
    v_pk_fma_f32 v[158:159], v[162:163], v[16:17], v[158:159] op_sel:[0,1,0] op_sel_hi:[1,1,1]
    s_waitcnt vmcnt(6)
    buffer_load_dwordx4 v[108:111], v2, s[32:35], s70 offen offset:1024 nt
    s_waitcnt vmcnt(6)
    buffer_load_dwordx4 v[112:115], v2, s[32:35], s70 offen offset:2048 nt
    v_lshlrev_b32 v160, 16, v92
    v_and_b32 v161, 0xffff0000, v92
    v_pk_fma_f32 v[144:145], v[160:161], v[18:19], v[144:145] op_sel:[0,0,0] op_sel_hi:[1,0,1]
    v_pk_fma_f32 v[152:153], v[160:161], v[18:19], v[152:153] op_sel:[0,1,0] op_sel_hi:[1,1,1]
    v_lshlrev_b32 v162, 16, v93
    v_and_b32 v163, 0xffff0000, v93
    v_pk_fma_f32 v[146:147], v[162:163], v[18:19], v[146:147] op_sel:[0,0,0] op_sel_hi:[1,0,1]
    v_pk_fma_f32 v[154:155], v[162:163], v[18:19], v[154:155] op_sel:[0,1,0] op_sel_hi:[1,1,1]
    v_lshlrev_b32 v160, 16, v94
    v_and_b32 v161, 0xffff0000, v94
    v_pk_fma_f32 v[148:149], v[160:161], v[18:19], v[148:149] op_sel:[0,0,0] op_sel_hi:[1,0,1]
    v_pk_fma_f32 v[156:157], v[160:161], v[18:19], v[156:157] op_sel:[0,1,0] op_sel_hi:[1,1,1]
    v_lshlrev_b32 v162, 16, v95
    v_and_b32 v163, 0xffff0000, v95
    v_pk_fma_f32 v[150:151], v[162:163], v[18:19], v[150:151] op_sel:[0,0,0] op_sel_hi:[1,0,1]
    v_pk_fma_f32 v[158:159], v[162:163], v[18:19], v[158:159] op_sel:[0,1,0] op_sel_hi:[1,1,1]
    s_waitcnt vmcnt(6)
    buffer_load_dwordx4 v[116:119], v2, s[32:35], s70 offen offset:3072 nt
    s_waitcnt vmcnt(6)
    buffer_load_dwordx4 v[120:123], v2, s[32:35], s71 offen offset:0 nt
    v_lshlrev_b32 v160, 16, v96
    v_and_b32 v161, 0xffff0000, v96
    v_pk_fma_f32 v[144:145], v[160:161], v[20:21], v[144:145] op_sel:[0,0,0] op_sel_hi:[1,0,1]
    v_pk_fma_f32 v[152:153], v[160:161], v[20:21], v[152:153] op_sel:[0,1,0] op_sel_hi:[1,1,1]
    v_lshlrev_b32 v162, 16, v97
    v_and_b32 v163, 0xffff0000, v97
    v_pk_fma_f32 v[146:147], v[162:163], v[20:21], v[146:147] op_sel:[0,0,0] op_sel_hi:[1,0,1]
    v_pk_fma_f32 v[154:155], v[162:163], v[20:21], v[154:155] op_sel:[0,1,0] op_sel_hi:[1,1,1]
    v_lshlrev_b32 v160, 16, v98
    v_and_b32 v161, 0xffff0000, v98
    v_pk_fma_f32 v[148:149], v[160:161], v[20:21], v[148:149] op_sel:[0,0,0] op_sel_hi:[1,0,1]
    v_pk_fma_f32 v[156:157], v[160:161], v[20:21], v[156:157] op_sel:[0,1,0] op_sel_hi:[1,1,1]
    v_lshlrev_b32 v162, 16, v99
    v_and_b32 v163, 0xffff0000, v99
    v_pk_fma_f32 v[150:151], v[162:163], v[20:21], v[150:151] op_sel:[0,0,0] op_sel_hi:[1,0,1]
    v_pk_fma_f32 v[158:159], v[162:163], v[20:21], v[158:159] op_sel:[0,1,0] op_sel_hi:[1,1,1]
    s_waitcnt vmcnt(6)
    buffer_load_dwordx4 v[124:127], v2, s[32:35], s71 offen offset:1024 nt
    s_waitcnt vmcnt(6)
    buffer_load_dwordx4 v[128:131], v2, s[32:35], s71 offen offset:2048 nt
    v_lshlrev_b32 v160, 16, v100
    v_and_b32 v161, 0xffff0000, v100
    v_pk_fma_f32 v[144:145], v[160:161], v[22:23], v[144:145] op_sel:[0,0,0] op_sel_hi:[1,0,1]
    v_pk_fma_f32 v[152:153], v[160:161], v[22:23], v[152:153] op_sel:[0,1,0] op_sel_hi:[1,1,1]
    v_lshlrev_b32 v162, 16, v101
    v_and_b32 v163, 0xffff0000, v101
    v_pk_fma_f32 v[146:147], v[162:163], v[22:23], v[146:147] op_sel:[0,0,0] op_sel_hi:[1,0,1]
    v_pk_fma_f32 v[154:155], v[162:163], v[22:23], v[154:155] op_sel:[0,1,0] op_sel_hi:[1,1,1]
    v_lshlrev_b32 v160, 16, v102
    v_and_b32 v161, 0xffff0000, v102
    v_pk_fma_f32 v[148:149], v[160:161], v[22:23], v[148:149] op_sel:[0,0,0] op_sel_hi:[1,0,1]
    v_pk_fma_f32 v[156:157], v[160:161], v[22:23], v[156:157] op_sel:[0,1,0] op_sel_hi:[1,1,1]
    v_lshlrev_b32 v162, 16, v103
    v_and_b32 v163, 0xffff0000, v103
    v_pk_fma_f32 v[150:151], v[162:163], v[22:23], v[150:151] op_sel:[0,0,0] op_sel_hi:[1,0,1]
    v_pk_fma_f32 v[158:159], v[162:163], v[22:23], v[158:159] op_sel:[0,1,0] op_sel_hi:[1,1,1]
    s_waitcnt vmcnt(6)
    buffer_load_dwordx4 v[132:135], v2, s[32:35], s71 offen offset:3072 nt
    v_lshlrev_b32 v160, 16, v104
    v_and_b32 v161, 0xffff0000, v104
    v_pk_fma_f32 v[144:145], v[160:161], v[24:25], v[144:145] op_sel:[0,0,0] op_sel_hi:[1,0,1]
    v_pk_fma_f32 v[152:153], v[160:161], v[24:25], v[152:153] op_sel:[0,1,0] op_sel_hi:[1,1,1]
    v_lshlrev_b32 v162, 16, v105
    v_and_b32 v163, 0xffff0000, v105
    v_pk_fma_f32 v[146:147], v[162:163], v[24:25], v[146:147] op_sel:[0,0,0] op_sel_hi:[1,0,1]
    v_pk_fma_f32 v[154:155], v[162:163], v[24:25], v[154:155] op_sel:[0,1,0] op_sel_hi:[1,1,1]
    v_lshlrev_b32 v160, 16, v106
    v_and_b32 v161, 0xffff0000, v106
    v_pk_fma_f32 v[148:149], v[160:161], v[24:25], v[148:149] op_sel:[0,0,0] op_sel_hi:[1,0,1]
    v_pk_fma_f32 v[156:157], v[160:161], v[24:25], v[156:157] op_sel:[0,1,0] op_sel_hi:[1,1,1]
    v_lshlrev_b32 v162, 16, v107
    v_and_b32 v163, 0xffff0000, v107
    v_pk_fma_f32 v[150:151], v[162:163], v[24:25], v[150:151] op_sel:[0,0,0] op_sel_hi:[1,0,1]
    v_pk_fma_f32 v[158:159], v[162:163], v[24:25], v[158:159] op_sel:[0,1,0] op_sel_hi:[1,1,1]
    s_waitcnt vmcnt(6)
    v_lshlrev_b32 v160, 16, v108
    v_and_b32 v161, 0xffff0000, v108
    v_pk_fma_f32 v[144:145], v[160:161], v[26:27], v[144:145] op_sel:[0,0,0] op_sel_hi:[1,0,1]
    v_pk_fma_f32 v[152:153], v[160:161], v[26:27], v[152:153] op_sel:[0,1,0] op_sel_hi:[1,1,1]
    v_lshlrev_b32 v162, 16, v109
    v_and_b32 v163, 0xffff0000, v109
    v_pk_fma_f32 v[146:147], v[162:163], v[26:27], v[146:147] op_sel:[0,0,0] op_sel_hi:[1,0,1]
    v_pk_fma_f32 v[154:155], v[162:163], v[26:27], v[154:155] op_sel:[0,1,0] op_sel_hi:[1,1,1]
    v_lshlrev_b32 v160, 16, v110
    v_and_b32 v161, 0xffff0000, v110
    v_pk_fma_f32 v[148:149], v[160:161], v[26:27], v[148:149] op_sel:[0,0,0] op_sel_hi:[1,0,1]
    v_pk_fma_f32 v[156:157], v[160:161], v[26:27], v[156:157] op_sel:[0,1,0] op_sel_hi:[1,1,1]
    v_lshlrev_b32 v162, 16, v111
    v_and_b32 v163, 0xffff0000, v111
    v_pk_fma_f32 v[150:151], v[162:163], v[26:27], v[150:151] op_sel:[0,0,0] op_sel_hi:[1,0,1]
    v_pk_fma_f32 v[158:159], v[162:163], v[26:27], v[158:159] op_sel:[0,1,0] op_sel_hi:[1,1,1]
    s_waitcnt vmcnt(5)
    v_lshlrev_b32 v160, 16, v112
    v_and_b32 v161, 0xffff0000, v112
    v_pk_fma_f32 v[144:145], v[160:161], v[28:29], v[144:145] op_sel:[0,0,0] op_sel_hi:[1,0,1]
    v_pk_fma_f32 v[152:153], v[160:161], v[28:29], v[152:153] op_sel:[0,1,0] op_sel_hi:[1,1,1]
    v_lshlrev_b32 v162, 16, v113
    v_and_b32 v163, 0xffff0000, v113
    v_pk_fma_f32 v[146:147], v[162:163], v[28:29], v[146:147] op_sel:[0,0,0] op_sel_hi:[1,0,1]
    v_pk_fma_f32 v[154:155], v[162:163], v[28:29], v[154:155] op_sel:[0,1,0] op_sel_hi:[1,1,1]
    v_lshlrev_b32 v160, 16, v114
    v_and_b32 v161, 0xffff0000, v114
    v_pk_fma_f32 v[148:149], v[160:161], v[28:29], v[148:149] op_sel:[0,0,0] op_sel_hi:[1,0,1]
    v_pk_fma_f32 v[156:157], v[160:161], v[28:29], v[156:157] op_sel:[0,1,0] op_sel_hi:[1,1,1]
    v_lshlrev_b32 v162, 16, v115
    v_and_b32 v163, 0xffff0000, v115
    v_pk_fma_f32 v[150:151], v[162:163], v[28:29], v[150:151] op_sel:[0,0,0] op_sel_hi:[1,0,1]
    v_pk_fma_f32 v[158:159], v[162:163], v[28:29], v[158:159] op_sel:[0,1,0] op_sel_hi:[1,1,1]
    s_waitcnt vmcnt(4)
    v_lshlrev_b32 v160, 16, v116
    v_and_b32 v161, 0xffff0000, v116
    v_pk_fma_f32 v[144:145], v[160:161], v[30:31], v[144:145] op_sel:[0,0,0] op_sel_hi:[1,0,1]
    v_pk_fma_f32 v[152:153], v[160:161], v[30:31], v[152:153] op_sel:[0,1,0] op_sel_hi:[1,1,1]
    v_lshlrev_b32 v162, 16, v117
    v_and_b32 v163, 0xffff0000, v117
    v_pk_fma_f32 v[146:147], v[162:163], v[30:31], v[146:147] op_sel:[0,0,0] op_sel_hi:[1,0,1]
    v_pk_fma_f32 v[154:155], v[162:163], v[30:31], v[154:155] op_sel:[0,1,0] op_sel_hi:[1,1,1]
    v_lshlrev_b32 v160, 16, v118
    v_and_b32 v161, 0xffff0000, v118
    v_pk_fma_f32 v[148:149], v[160:161], v[30:31], v[148:149] op_sel:[0,0,0] op_sel_hi:[1,0,1]
    v_pk_fma_f32 v[156:157], v[160:161], v[30:31], v[156:157] op_sel:[0,1,0] op_sel_hi:[1,1,1]
    v_lshlrev_b32 v162, 16, v119
    v_and_b32 v163, 0xffff0000, v119
    v_pk_fma_f32 v[150:151], v[162:163], v[30:31], v[150:151] op_sel:[0,0,0] op_sel_hi:[1,0,1]
    v_pk_fma_f32 v[158:159], v[162:163], v[30:31], v[158:159] op_sel:[0,1,0] op_sel_hi:[1,1,1]
    s_waitcnt vmcnt(3)
    v_lshlrev_b32 v160, 16, v120
    v_and_b32 v161, 0xffff0000, v120
    v_pk_fma_f32 v[144:145], v[160:161], v[32:33], v[144:145] op_sel:[0,0,0] op_sel_hi:[1,0,1]
    v_pk_fma_f32 v[152:153], v[160:161], v[32:33], v[152:153] op_sel:[0,1,0] op_sel_hi:[1,1,1]
    v_lshlrev_b32 v162, 16, v121
    v_and_b32 v163, 0xffff0000, v121
    v_pk_fma_f32 v[146:147], v[162:163], v[32:33], v[146:147] op_sel:[0,0,0] op_sel_hi:[1,0,1]
    v_pk_fma_f32 v[154:155], v[162:163], v[32:33], v[154:155] op_sel:[0,1,0] op_sel_hi:[1,1,1]
    v_lshlrev_b32 v160, 16, v122
    v_and_b32 v161, 0xffff0000, v122
    v_pk_fma_f32 v[148:149], v[160:161], v[32:33], v[148:149] op_sel:[0,0,0] op_sel_hi:[1,0,1]
    v_pk_fma_f32 v[156:157], v[160:161], v[32:33], v[156:157] op_sel:[0,1,0] op_sel_hi:[1,1,1]
    v_lshlrev_b32 v162, 16, v123
    v_and_b32 v163, 0xffff0000, v123
    v_pk_fma_f32 v[150:151], v[162:163], v[32:33], v[150:151] op_sel:[0,0,0] op_sel_hi:[1,0,1]
    v_pk_fma_f32 v[158:159], v[162:163], v[32:33], v[158:159] op_sel:[0,1,0] op_sel_hi:[1,1,1]
    s_waitcnt vmcnt(2)
    v_lshlrev_b32 v160, 16, v124
    v_and_b32 v161, 0xffff0000, v124
    v_pk_fma_f32 v[144:145], v[160:161], v[34:35], v[144:145] op_sel:[0,0,0] op_sel_hi:[1,0,1]
    v_pk_fma_f32 v[152:153], v[160:161], v[34:35], v[152:153] op_sel:[0,1,0] op_sel_hi:[1,1,1]
    v_lshlrev_b32 v162, 16, v125
    v_and_b32 v163, 0xffff0000, v125
    v_pk_fma_f32 v[146:147], v[162:163], v[34:35], v[146:147] op_sel:[0,0,0] op_sel_hi:[1,0,1]
    v_pk_fma_f32 v[154:155], v[162:163], v[34:35], v[154:155] op_sel:[0,1,0] op_sel_hi:[1,1,1]
    v_lshlrev_b32 v160, 16, v126
    v_and_b32 v161, 0xffff0000, v126
    v_pk_fma_f32 v[148:149], v[160:161], v[34:35], v[148:149] op_sel:[0,0,0] op_sel_hi:[1,0,1]
    v_pk_fma_f32 v[156:157], v[160:161], v[34:35], v[156:157] op_sel:[0,1,0] op_sel_hi:[1,1,1]
    v_lshlrev_b32 v162, 16, v127
    v_and_b32 v163, 0xffff0000, v127
    v_pk_fma_f32 v[150:151], v[162:163], v[34:35], v[150:151] op_sel:[0,0,0] op_sel_hi:[1,0,1]
    v_pk_fma_f32 v[158:159], v[162:163], v[34:35], v[158:159] op_sel:[0,1,0] op_sel_hi:[1,1,1]
    s_waitcnt vmcnt(1)
    v_lshlrev_b32 v160, 16, v128
    v_and_b32 v161, 0xffff0000, v128
    v_pk_fma_f32 v[144:145], v[160:161], v[36:37], v[144:145] op_sel:[0,0,0] op_sel_hi:[1,0,1]
    v_pk_fma_f32 v[152:153], v[160:161], v[36:37], v[152:153] op_sel:[0,1,0] op_sel_hi:[1,1,1]
    v_lshlrev_b32 v162, 16, v129
    v_and_b32 v163, 0xffff0000, v129
    v_pk_fma_f32 v[146:147], v[162:163], v[36:37], v[146:147] op_sel:[0,0,0] op_sel_hi:[1,0,1]
    v_pk_fma_f32 v[154:155], v[162:163], v[36:37], v[154:155] op_sel:[0,1,0] op_sel_hi:[1,1,1]
    v_lshlrev_b32 v160, 16, v130
    v_and_b32 v161, 0xffff0000, v130
    v_pk_fma_f32 v[148:149], v[160:161], v[36:37], v[148:149] op_sel:[0,0,0] op_sel_hi:[1,0,1]
    v_pk_fma_f32 v[156:157], v[160:161], v[36:37], v[156:157] op_sel:[0,1,0] op_sel_hi:[1,1,1]
    v_lshlrev_b32 v162, 16, v131
    v_and_b32 v163, 0xffff0000, v131
    v_pk_fma_f32 v[150:151], v[162:163], v[36:37], v[150:151] op_sel:[0,0,0] op_sel_hi:[1,0,1]
    v_pk_fma_f32 v[158:159], v[162:163], v[36:37], v[158:159] op_sel:[0,1,0] op_sel_hi:[1,1,1]
    s_waitcnt vmcnt(0)
    v_lshlrev_b32 v160, 16, v132
    v_and_b32 v161, 0xffff0000, v132
    v_pk_fma_f32 v[144:145], v[160:161], v[38:39], v[144:145] op_sel:[0,0,0] op_sel_hi:[1,0,1]
    v_pk_fma_f32 v[152:153], v[160:161], v[38:39], v[152:153] op_sel:[0,1,0] op_sel_hi:[1,1,1]
    v_lshlrev_b32 v162, 16, v133
    v_and_b32 v163, 0xffff0000, v133
    v_pk_fma_f32 v[146:147], v[162:163], v[38:39], v[146:147] op_sel:[0,0,0] op_sel_hi:[1,0,1]
    v_pk_fma_f32 v[154:155], v[162:163], v[38:39], v[154:155] op_sel:[0,1,0] op_sel_hi:[1,1,1]
    v_lshlrev_b32 v160, 16, v134
    v_and_b32 v161, 0xffff0000, v134
    v_pk_fma_f32 v[148:149], v[160:161], v[38:39], v[148:149] op_sel:[0,0,0] op_sel_hi:[1,0,1]
    v_pk_fma_f32 v[156:157], v[160:161], v[38:39], v[156:157] op_sel:[0,1,0] op_sel_hi:[1,1,1]
    v_lshlrev_b32 v162, 16, v135
    v_and_b32 v163, 0xffff0000, v135
    v_pk_fma_f32 v[150:151], v[162:163], v[38:39], v[150:151] op_sel:[0,0,0] op_sel_hi:[1,0,1]
    v_pk_fma_f32 v[158:159], v[162:163], v[38:39], v[158:159] op_sel:[0,1,0] op_sel_hi:[1,1,1]
L_vphase_done:
    s_nop 4
    v_pk_mul_f32 v[144:145], v[144:145], v[58:59] op_sel:[0,0] op_sel_hi:[1,0]
    v_pk_mul_f32 v[152:153], v[152:153], v[58:59] op_sel:[0,1] op_sel_hi:[1,1]
    v_pk_mul_f32 v[146:147], v[146:147], v[58:59] op_sel:[0,0] op_sel_hi:[1,0]
    v_pk_mul_f32 v[154:155], v[154:155], v[58:59] op_sel:[0,1] op_sel_hi:[1,1]
    v_pk_mul_f32 v[148:149], v[148:149], v[58:59] op_sel:[0,0] op_sel_hi:[1,0]
    v_pk_mul_f32 v[156:157], v[156:157], v[58:59] op_sel:[0,1] op_sel_hi:[1,1]
    v_pk_mul_f32 v[150:151], v[150:151], v[58:59] op_sel:[0,0] op_sel_hi:[1,0]
    v_pk_mul_f32 v[158:159], v[158:159], v[58:59] op_sel:[0,1] op_sel_hi:[1,1]
    v_permlane32_swap_b32 v144, v152
    v_permlane32_swap_b32 v145, v153
    v_permlane32_swap_b32 v146, v154
    v_permlane32_swap_b32 v147, v155
    v_permlane32_swap_b32 v148, v156
    v_permlane32_swap_b32 v149, v157
    v_permlane32_swap_b32 v150, v158
    v_permlane32_swap_b32 v151, v159
    v_add_f32 v144, v144, v152
    v_add_f32 v145, v145, v153
    v_add_f32 v146, v146, v154
    v_add_f32 v147, v147, v155
    v_add_f32 v148, v148, v156
    v_add_f32 v149, v149, v157
    v_add_f32 v150, v150, v158
    v_add_f32 v151, v151, v159
    v_lshlrev_b32 v7, 5, v1
    s_lshl_b32 s78, s3, 11
    s_add_u32 s78, s78, 128000
    v_add_u32 v7, s78, v7
    ds_write_b128 v7, v[144:147]
    ds_write_b128 v7, v[148:151] offset:16
    s_waitcnt lgkmcnt(0)
    s_barrier
L_tail:
    s_cmp_ge_u32 s3, 4
    s_cbranch_scc1 L_pub_done
    v_lshlrev_b32 v7, 3, v0
    v_add_u32 v7, 128000, v7
    ds_read_b64 v[8:9], v7 offset:0
    ds_read_b64 v[10:11], v7 offset:2048
    ds_read_b64 v[12:13], v7 offset:4096
    ds_read_b64 v[14:15], v7 offset:6144
    ds_read_b64 v[16:17], v7 offset:8192
    ds_read_b64 v[18:19], v7 offset:10240
    ds_read_b64 v[20:21], v7 offset:12288
    ds_read_b64 v[22:23], v7 offset:14336
    s_lshr_b32 s84, s3, 1
    s_lshl_b32 s85, s84, 5
    v_mov_b32 v6, s85
    ds_read_b128 v[24:27], v6 offset:3136
    ds_read_b128 v[28:31], v6 offset:3152
    s_lshl_b32 s78, s72, 4
    s_lshl_b32 s79, s73, 1
    s_add_u32 s78, s78, s79
    s_add_u32 s78, s78, s84
    s_lshl_b32 s79, s78, 13
    s_lshl_b32 s85, s74, 6
    s_add_u32 s79, s79, s85
    s_add_u32 s79, s79, 524288
    s_add_u32 s85, s79, 327680
    v_bfe_u32 v6, v0, 4, 3
    v_lshlrev_b32 v6, 10, v6
    v_and_b32 v5, 15, v0
    v_lshl_add_u32 v6, v5, 2, v6
    s_waitcnt lgkmcnt(2)
    v_pk_add_f32 v[8:9], v[8:9], v[16:17]
    v_pk_add_f32 v[10:11], v[10:11], v[18:19]
    v_pk_add_f32 v[12:13], v[12:13], v[20:21]
    v_pk_add_f32 v[14:15], v[14:15], v[22:23]
    v_pk_add_f32 v[8:9], v[8:9], v[12:13]
    v_pk_add_f32 v[10:11], v[10:11], v[14:15]
    v_pk_add_f32 v[8:9], v[8:9], v[10:11]
    v_cvt_pk_bf16_f32 v8, v8, v9
    buffer_store_dword v8, v6, s[36:39], s79 offen
    buffer_store_dword v8, v6, s[36:39], s85 offen sc1
    s_bitcmp1_b32 s3, 0
    s_cbranch_scc0 L_pub_even
    s_branch L_pub_done
L_pub_even:
    s_nop 4
    s_waitcnt lgkmcnt(0)
    v_pk_add_f32 v[24:25], v[24:25], v[26:27]
    v_pk_add_f32 v[28:29], v[28:29], v[30:31]
    v_pk_add_f32 v[24:25], v[24:25], v[28:29]
    v_add_f32 v25, v24, v25
    s_cmp_eq_u32 s84, 1
    s_cselect_b64 vcc, -1, 0
    v_cndmask_b32 v24, v60, v61, vcc
    s_lshl_b32 s79, s78, 4
    s_add_u32 s79, s79, s74
    s_lshl_b32 s79, s79, 3
    s_add_u32 s79, s79, 786432
    s_add_u32 s85, s79, 327680
    v_mov_b32 v6, 0
    s_mov_b64 exec, 1
    buffer_store_dwordx2 v[24:25], v6, s[36:39], s79 offen
    buffer_store_dwordx2 v[24:25], v6, s[36:39], s85 offen sc1
    s_mov_b64 exec, -1
L_pub_done:
    s_nop 4
    s_cmp_eq_u32 s100, 0
    s_cbranch_scc1 L_dma_done2
    s_cmp_lt_u32 s3, 4
    s_cbranch_scc1 L_dma_done2
    s_and_b32 s84, s3, 3
    s_lshl_b32 s84, s84, 1
    s_mul_i32 s94, s84, 200704
    s_lshl_b32 s79, s77, 7
    s_add_u32 s94, s94, s79
    s_add_u32 s94, s94, 114688
    s_mul_i32 s95, s84, 7168
    s_add_u32 s95, s95, 17408
    s_mov_b32 m0, s95
    s_nop 0
    buffer_load_dwordx4 v64, s[44:47], s94 offen nt lds
    s_add_u32 s94, s94, s88
    s_add_u32 s95, s95, 1024
    s_mov_b32 m0, s95
    s_nop 0
    buffer_load_dwordx4 v64, s[44:47], s94 offen nt lds
    s_add_u32 s94, s94, s88
    s_add_u32 s95, s95, 1024
    s_mov_b32 m0, s95
    s_nop 0
    buffer_load_dwordx4 v64, s[44:47], s94 offen nt lds
    s_add_u32 s94, s94, s88
    s_add_u32 s95, s95, 1024
    s_add_u32 s84, s84, 1
    s_mul_i32 s94, s84, 200704
    s_lshl_b32 s79, s77, 7
    s_add_u32 s94, s94, s79
    s_add_u32 s94, s94, 114688
    s_mul_i32 s95, s84, 7168
    s_add_u32 s95, s95, 17408
    s_mov_b32 m0, s95
    s_nop 0
    buffer_load_dwordx4 v64, s[44:47], s94 offen nt lds
    s_add_u32 s94, s94, s88
    s_add_u32 s95, s95, 1024
    s_mov_b32 m0, s95
    s_nop 0
    buffer_load_dwordx4 v64, s[44:47], s94 offen nt lds
    s_add_u32 s94, s94, s88
    s_add_u32 s95, s95, 1024
    s_mov_b32 m0, s95
    s_nop 0
    buffer_load_dwordx4 v64, s[44:47], s94 offen nt lds
    s_add_u32 s94, s94, s88
    s_add_u32 s95, s95, 1024
    s_add_u32 s84, s84, 1
    s_waitcnt vmcnt(0)
    s_barrier
L_dma_done2:
    s_nop 4
    v_lshrrev_b32 v5, 4, v1
    v_bfe_u32 v6, v1, 2, 2
    v_lshl_add_u32 v5, v5, 3, v6
    v_and_b32 v6, 3, v1
    v_lshlrev_b32 v6, 3, v6
    v_lshl_add_u32 v148, v5, 6, v6
    v_lshl_add_u32 v149, v5, 7, v6
    v_mul_u32_u24 v167, 896, v5
    v_add_u32 v167, v167, v6
    s_sub_u32 s96, s3, 4
    s_cmp_ge_u32 s96, 2
    s_cbranch_scc1 L_B_done
    s_cmp_ge_u32 s91, 28
    s_cbranch_scc1 L_B_done
    v_mov_b32 v7, 0
    ds_read_b32 v7, v7 offset:3264
    ds_read_b64_tr_b16 v[8:9], v148 offset:13312
    ds_read_b64_tr_b16 v[10:11], v148 offset:13568
    ds_read_b64_tr_b16 v[12:13], v148 offset:15360
    ds_read_b64_tr_b16 v[14:15], v148 offset:15616
    ds_read_b64_tr_b16 v[16:17], v148 offset:17408
    ds_read_b64_tr_b16 v[18:19], v148 offset:17664
    ds_read_b64_tr_b16 v[20:21], v148 offset:19456
    ds_read_b64_tr_b16 v[22:23], v148 offset:19712
    ds_read_b64_tr_b16 v[24:25], v148 offset:21504
    ds_read_b64_tr_b16 v[26:27], v148 offset:21760
    ds_read_b64_tr_b16 v[28:29], v148 offset:23552
    ds_read_b64_tr_b16 v[30:31], v148 offset:23808
    ds_read_b64_tr_b16 v[32:33], v148 offset:25600
    ds_read_b64_tr_b16 v[34:35], v148 offset:25856
    ds_read_b64_tr_b16 v[36:37], v148 offset:27648
    ds_read_b64_tr_b16 v[38:39], v148 offset:27904
    ds_read_b64_tr_b16 v[40:41], v148 offset:13344
    ds_read_b64_tr_b16 v[42:43], v148 offset:13600
    ds_read_b64_tr_b16 v[44:45], v148 offset:15392
    ds_read_b64_tr_b16 v[46:47], v148 offset:15648
    ds_read_b64_tr_b16 v[48:49], v148 offset:17440
    ds_read_b64_tr_b16 v[50:51], v148 offset:17696
    ds_read_b64_tr_b16 v[52:53], v148 offset:19488
    ds_read_b64_tr_b16 v[54:55], v148 offset:19744
    ds_read_b64_tr_b16 v[56:57], v148 offset:21536
    ds_read_b64_tr_b16 v[58:59], v148 offset:21792
    ds_read_b64_tr_b16 v[60:61], v148 offset:23584
    ds_read_b64_tr_b16 v[62:63], v148 offset:23840
    ds_read_b64_tr_b16 v[64:65], v148 offset:25632
    ds_read_b64_tr_b16 v[66:67], v148 offset:25888
    ds_read_b64_tr_b16 v[68:69], v148 offset:27680
    ds_read_b64_tr_b16 v[70:71], v148 offset:27936
    s_lshl_b32 s84, s96, 4
    s_add_u32 s84, s84, s75
    s_lshl_b32 s85, s84, 13
    s_add_u32 s85, s85, 524288
    s_lshl_b32 s84, s84, 7
    s_add_u32 s84, s84, 786432
    v_and_b32 v6, 15, v1
    v_lshlrev_b32 v6, 6, v6
    v_lshrrev_b32 v5, 4, v1
    v_lshl_add_u32 v6, v5, 4, v6
    v_lshlrev_b32 v5, 5, v5
    v_mov_b32 v112, 0
    v_mov_b32 v113, 0
    v_mov_b32 v114, 0
    v_mov_b32 v115, 0
    v_mov_b32 v116, 0
    v_mov_b32 v117, 0
    v_mov_b32 v118, 0
    v_mov_b32 v119, 0
    s_waitcnt lgkmcnt(15)
    s_waitcnt lgkmcnt(15)
    v_readfirstlane_b32 s78, v7
    s_nop 0
    s_add_u32 s85, s85, s78
    s_add_u32 s84, s84, s78
    s_add_u32 s79, s85, 4096
L_pollB:
    s_nop 4
    buffer_load_dwordx4 v[72:75], v6, s[36:39], s85 offen offset:0 sc1
    buffer_load_dwordx4 v[76:79], v6, s[36:39], s85 offen offset:1024 sc1
    buffer_load_dwordx4 v[80:83], v6, s[36:39], s85 offen offset:2048 sc1
    buffer_load_dwordx4 v[84:87], v6, s[36:39], s85 offen offset:3072 sc1
    buffer_load_dwordx4 v[88:91], v6, s[36:39], s79 offen offset:0 sc1
    buffer_load_dwordx4 v[92:95], v6, s[36:39], s79 offen offset:1024 sc1
    buffer_load_dwordx4 v[96:99], v6, s[36:39], s79 offen offset:2048 sc1
    buffer_load_dwordx4 v[100:103], v6, s[36:39], s79 offen offset:3072 sc1
    buffer_load_dwordx4 v[104:107], v5, s[36:39], s84 offen sc1
    buffer_load_dwordx4 v[108:111], v5, s[36:39], s84 offen offset:16 sc1
    s_waitcnt vmcnt(0)
    v_max_u32 v160, v72, v73
    v_max3_u32 v160, v160, v74, v75
    v_max3_u32 v160, v160, v76, v77
    v_max3_u32 v160, v160, v78, v79
    v_max3_u32 v160, v160, v80, v81
    v_max3_u32 v160, v160, v82, v83
    v_max3_u32 v160, v160, v84, v85
    v_max3_u32 v160, v160, v86, v87
    v_max3_u32 v160, v160, v88, v89
    v_max3_u32 v160, v160, v90, v91
    v_max3_u32 v160, v160, v92, v93
    v_max3_u32 v160, v160, v94, v95
    v_max3_u32 v160, v160, v96, v97
    v_max3_u32 v160, v160, v98, v99
    v_max3_u32 v160, v160, v100, v101
    v_max3_u32 v160, v160, v102, v103
    v_max3_u32 v160, v160, v104, v105
    v_max3_u32 v160, v160, v106, v107
    v_max3_u32 v160, v160, v108, v109
    v_max3_u32 v160, v160, v110, v111
    v_cmp_eq_u32 vcc, -1, v160
    s_sub_u32 s87, s87, 1
    s_cmp_eq_u32 s87, 0
    s_cbranch_scc1 L_pollB_x
    s_mov_b64 exec, vcc
    s_cbranch_vccnz L_pollB
L_pollB_x:
    s_nop 4
    s_mov_b64 exec, -1
    s_waitcnt lgkmcnt(0)
    v_mfma_f32_16x16x32_bf16 v[112:115], v[72:75], v[8:11], v[112:115]
    v_mfma_f32_16x16x32_bf16 v[116:119], v[72:75], v[40:43], v[116:119]
    v_mfma_f32_16x16x32_bf16 v[112:115], v[76:79], v[12:15], v[112:115]
    v_mfma_f32_16x16x32_bf16 v[116:119], v[76:79], v[44:47], v[116:119]
    v_mfma_f32_16x16x32_bf16 v[112:115], v[80:83], v[16:19], v[112:115]
    v_mfma_f32_16x16x32_bf16 v[116:119], v[80:83], v[48:51], v[116:119]
    v_mfma_f32_16x16x32_bf16 v[112:115], v[84:87], v[20:23], v[112:115]
    v_mfma_f32_16x16x32_bf16 v[116:119], v[84:87], v[52:55], v[116:119]
    v_mfma_f32_16x16x32_bf16 v[112:115], v[88:91], v[24:27], v[112:115]
    v_mfma_f32_16x16x32_bf16 v[116:119], v[88:91], v[56:59], v[116:119]
    v_mfma_f32_16x16x32_bf16 v[112:115], v[92:95], v[28:31], v[112:115]
    v_mfma_f32_16x16x32_bf16 v[116:119], v[92:95], v[60:63], v[116:119]
    v_mfma_f32_16x16x32_bf16 v[112:115], v[96:99], v[32:35], v[112:115]
    v_mfma_f32_16x16x32_bf16 v[116:119], v[96:99], v[64:67], v[116:119]
    v_mfma_f32_16x16x32_bf16 v[112:115], v[100:103], v[36:39], v[112:115]
    v_mfma_f32_16x16x32_bf16 v[116:119], v[100:103], v[68:71], v[116:119]
    v_max3_f32 v160, v104, v106, v108
    v_max_f32 v160, v160, v110
    v_mov_b32 v161, v160
    s_nop 1
    v_permlane16_swap_b32 v160, v161
    v_max_f32 v160, v160, v161
    v_mov_b32 v161, v160
    s_nop 1
    v_permlane32_swap_b32 v160, v161
    v_max_f32 v160, v160, v161
    v_sub_f32 v104, v104, v160
    v_sub_f32 v106, v106, v160
    v_sub_f32 v108, v108, v160
    v_sub_f32 v110, v110, v160
    v_exp_f32 v104, v104
    v_exp_f32 v106, v106
    v_exp_f32 v108, v108
    v_exp_f32 v110, v110
    v_mul_f32 v162, v104, v105
    v_fmac_f32 v162, v106, v107
    v_fmac_f32 v162, v108, v109
    v_fmac_f32 v162, v110, v111
    v_mov_b32 v161, v162
    s_nop 1
    v_permlane16_swap_b32 v162, v161
    v_add_f32 v162, v162, v161
    v_mov_b32 v161, v162
    s_nop 1
    v_permlane32_swap_b32 v162, v161
    v_add_f32 v162, v162, v161
    v_rcp_f32 v162, v162
    v_and_b32 v6, 31, v1
    v_lshlrev_b32 v6, 2, v6
    s_mul_i32 s84, s75, 3584
    s_mul_i32 s85, s96, 1792
    s_add_u32 s84, s84, s85
    s_lshl_b32 s85, s76, 7
    s_add_u32 s84, s84, s85
    s_add_u32 s84, s84, 1122304
    v_mul_f32 v164, v104, v112
    v_mul_f32 v165, v104, v116
    v_fmac_f32 v164, v106, v113
    v_fmac_f32 v165, v106, v117
    v_fmac_f32 v164, v108, v114
    v_fmac_f32 v165, v108, v118
    v_fmac_f32 v164, v110, v115
    v_fmac_f32 v165, v110, v119
    s_nop 1
    v_permlane16_swap_b32 v164, v165
    v_add_f32 v164, v164, v165
    v_mov_b32 v161, v164
    s_nop 1
    v_permlane32_swap_b32 v164, v161
    v_add_f32 v164, v164, v161
    v_mul_f32 v164, v164, v162
    s_mov_b64 exec, 0xffffffff
    buffer_store_dword v164, v6, s[36:39], s84 offen sc1
    s_mov_b64 exec, -1
L_B_done:
    s_nop 4
    s_cmp_eq_u32 s100, 0
    s_cbranch_scc1 L_fin
    s_cmp_lt_u32 s3, 4
    s_cbranch_scc1 L_C_gather
    s_and_b32 s79, s3, 3
    s_lshl_b32 s84, s79, 5
    s_add_u32 s84, s84, 13312
    v_add_u32 v7, s84, v149
    ds_read_b64_tr_b16 v[8:9], v7 offset:0
    ds_read_b64_tr_b16 v[10:11], v7 offset:512
    ds_read_b64_tr_b16 v[12:13], v7 offset:4096
    ds_read_b64_tr_b16 v[14:15], v7 offset:4608
    ds_read_b64_tr_b16 v[16:17], v7 offset:8192
    ds_read_b64_tr_b16 v[18:19], v7 offset:8704
    ds_read_b64_tr_b16 v[20:21], v7 offset:12288
    ds_read_b64_tr_b16 v[22:23], v7 offset:12800
    ds_read_b64_tr_b16 v[24:25], v7 offset:16384
    ds_read_b64_tr_b16 v[26:27], v7 offset:16896
    ds_read_b64_tr_b16 v[28:29], v7 offset:20480
    ds_read_b64_tr_b16 v[30:31], v7 offset:20992
    ds_read_b64_tr_b16 v[32:33], v7 offset:24576
    ds_read_b64_tr_b16 v[34:35], v7 offset:25088
    ds_read_b64_tr_b16 v[36:37], v7 offset:28672
    ds_read_b64_tr_b16 v[38:39], v7 offset:29184
    ds_read_b64_tr_b16 v[40:41], v7 offset:32768
    ds_read_b64_tr_b16 v[42:43], v7 offset:33280
    ds_read_b64_tr_b16 v[44:45], v7 offset:36864
    ds_read_b64_tr_b16 v[46:47], v7 offset:37376
    ds_read_b64_tr_b16 v[48:49], v7 offset:40960
    ds_read_b64_tr_b16 v[50:51], v7 offset:41472
    ds_read_b64_tr_b16 v[52:53], v7 offset:45056
    ds_read_b64_tr_b16 v[54:55], v7 offset:45568
    ds_read_b64_tr_b16 v[56:57], v7 offset:49152
    ds_read_b64_tr_b16 v[58:59], v7 offset:49664
    ds_read_b64_tr_b16 v[60:61], v7 offset:53248
    ds_read_b64_tr_b16 v[62:63], v7 offset:53760
    s_branch L_C_join
L_C_gather:
    s_nop 4
    v_lshlrev_b32 v7, 4, v0
    v_mov_b32 v6, 0x10000000
    v_cmp_gt_u32 vcc, 224, v0
    s_nop 1
    v_cndmask_b32 v7, v6, v7, vcc
    s_mov_b64 s[16:17], -1
    s_mov_b64 s[18:19], -1
    s_mov_b64 s[20:21], -1
    s_mov_b64 s[22:23], -1
    s_mov_b64 s[24:25], -1
    s_mov_b64 s[28:29], -1
    s_mov_b64 s[30:31], -1
    s_mov_b64 s[32:33], -1
    s_mov_b64 s[34:35], -1
    s_mov_b64 s[40:41], -1
    s_mov_b64 s[42:43], -1
    s_mov_b64 s[68:69], -1
    s_mov_b64 s[70:71], -1
    s_mov_b64 s[80:81], -1
    s_mov_b64 s[82:83], -1
    s_mov_b64 s[96:97], -1
    s_mov_b32 s85, 1
L_pollC:
    s_nop 4
    s_mov_b32 s78, 1122304
    s_mov_b64 exec, s[16:17]
    s_cbranch_execz L_pc0
    buffer_load_dwordx4 v[8:11], v7, s[36:39], s78 offen sc1
L_pc0:
    s_add_u32 s78, s78, 3584
    s_mov_b64 exec, s[18:19]
    s_cbranch_execz L_pc1
    buffer_load_dwordx4 v[12:15], v7, s[36:39], s78 offen sc1
L_pc1:
    s_add_u32 s78, s78, 3584
    s_mov_b64 exec, s[20:21]
    s_cbranch_execz L_pc2
    buffer_load_dwordx4 v[16:19], v7, s[36:39], s78 offen sc1
L_pc2:
    s_add_u32 s78, s78, 3584
    s_mov_b64 exec, s[22:23]
    s_cbranch_execz L_pc3
    buffer_load_dwordx4 v[20:23], v7, s[36:39], s78 offen sc1
L_pc3:
    s_add_u32 s78, s78, 3584
    s_mov_b64 exec, s[24:25]
    s_cbranch_execz L_pc4
    buffer_load_dwordx4 v[24:27], v7, s[36:39], s78 offen sc1
L_pc4:
    s_add_u32 s78, s78, 3584
    s_mov_b64 exec, s[28:29]
    s_cbranch_execz L_pc5
    buffer_load_dwordx4 v[28:31], v7, s[36:39], s78 offen sc1
L_pc5:
    s_add_u32 s78, s78, 3584
    s_mov_b64 exec, s[30:31]
    s_cbranch_execz L_pc6
    buffer_load_dwordx4 v[32:35], v7, s[36:39], s78 offen sc1
L_pc6:
    s_add_u32 s78, s78, 3584
    s_mov_b64 exec, s[32:33]
    s_cbranch_execz L_pc7
    buffer_load_dwordx4 v[36:39], v7, s[36:39], s78 offen sc1
L_pc7:
    s_add_u32 s78, s78, 3584
    s_mov_b64 exec, s[34:35]
    s_cbranch_execz L_pc8
    buffer_load_dwordx4 v[40:43], v7, s[36:39], s78 offen sc1
L_pc8:
    s_add_u32 s78, s78, 3584
    s_mov_b64 exec, s[40:41]
    s_cbranch_execz L_pc9
    buffer_load_dwordx4 v[44:47], v7, s[36:39], s78 offen sc1
L_pc9:
    s_add_u32 s78, s78, 3584
    s_mov_b64 exec, s[42:43]
    s_cbranch_execz L_pc10
    buffer_load_dwordx4 v[48:51], v7, s[36:39], s78 offen sc1
L_pc10:
    s_add_u32 s78, s78, 3584
    s_mov_b64 exec, s[68:69]
    s_cbranch_execz L_pc11
    buffer_load_dwordx4 v[52:55], v7, s[36:39], s78 offen sc1
L_pc11:
    s_add_u32 s78, s78, 3584
    s_mov_b64 exec, s[70:71]
    s_cbranch_execz L_pc12
    buffer_load_dwordx4 v[56:59], v7, s[36:39], s78 offen sc1
L_pc12:
    s_add_u32 s78, s78, 3584
    s_mov_b64 exec, s[80:81]
    s_cbranch_execz L_pc13
    buffer_load_dwordx4 v[60:63], v7, s[36:39], s78 offen sc1
L_pc13:
    s_add_u32 s78, s78, 3584
    s_mov_b64 exec, s[82:83]
    s_cbranch_execz L_pc14
    buffer_load_dwordx4 v[64:67], v7, s[36:39], s78 offen sc1
L_pc14:
    s_add_u32 s78, s78, 3584
    s_mov_b64 exec, s[96:97]
    s_cbranch_execz L_pc15
    buffer_load_dwordx4 v[68:71], v7, s[36:39], s78 offen sc1
L_pc15:
    s_mov_b64 exec, -1
    s_waitcnt vmcnt(0)
    s_cmp_eq_u32 s85, 0
    s_cbranch_scc1 L_pc_nb
    s_barrier
    s_mov_b32 s85, 0
L_pc_nb:
    v_max3_u32 v160, v8, v9, v10
    v_max_u32 v160, v160, v11
    v_cmp_eq_u32 s[16:17], -1, v160
    v_max3_u32 v161, v12, v13, v14
    v_max_u32 v161, v161, v15
    v_cmp_eq_u32 s[18:19], -1, v161
    v_max3_u32 v162, v16, v17, v18
    v_max_u32 v162, v162, v19
    v_cmp_eq_u32 s[20:21], -1, v162
    v_max3_u32 v163, v20, v21, v22
    v_max_u32 v163, v163, v23
    v_cmp_eq_u32 s[22:23], -1, v163
    v_max3_u32 v160, v24, v25, v26
    v_max_u32 v160, v160, v27
    v_cmp_eq_u32 s[24:25], -1, v160
    v_max3_u32 v161, v28, v29, v30
    v_max_u32 v161, v161, v31
    v_cmp_eq_u32 s[28:29], -1, v161
    v_max3_u32 v162, v32, v33, v34
    v_max_u32 v162, v162, v35
    v_cmp_eq_u32 s[30:31], -1, v162
    v_max3_u32 v163, v36, v37, v38
    v_max_u32 v163, v163, v39
    v_cmp_eq_u32 s[32:33], -1, v163
    v_max3_u32 v160, v40, v41, v42
    v_max_u32 v160, v160, v43
    v_cmp_eq_u32 s[34:35], -1, v160
    v_max3_u32 v161, v44, v45, v46
    v_max_u32 v161, v161, v47
    v_cmp_eq_u32 s[40:41], -1, v161
    v_max3_u32 v162, v48, v49, v50
    v_max_u32 v162, v162, v51
    v_cmp_eq_u32 s[42:43], -1, v162
    v_max3_u32 v163, v52, v53, v54
    v_max_u32 v163, v163, v55
    v_cmp_eq_u32 s[68:69], -1, v163
    v_max3_u32 v160, v56, v57, v58
    v_max_u32 v160, v160, v59
    v_cmp_eq_u32 s[70:71], -1, v160
    v_max3_u32 v161, v60, v61, v62
    v_max_u32 v161, v161, v63
    v_cmp_eq_u32 s[80:81], -1, v161
    v_max3_u32 v162, v64, v65, v66
    v_max_u32 v162, v162, v67
    v_cmp_eq_u32 s[82:83], -1, v162
    v_max3_u32 v163, v68, v69, v70
    v_max_u32 v163, v163, v71
    v_cmp_eq_u32 s[96:97], -1, v163
    s_nop 1
    s_or_b64 vcc, s[16:17], s[18:19]
    s_or_b64 vcc, vcc, s[20:21]
    s_or_b64 vcc, vcc, s[22:23]
    s_or_b64 vcc, vcc, s[24:25]
    s_or_b64 vcc, vcc, s[28:29]
    s_or_b64 vcc, vcc, s[30:31]
    s_or_b64 vcc, vcc, s[32:33]
    s_or_b64 vcc, vcc, s[34:35]
    s_or_b64 vcc, vcc, s[40:41]
    s_or_b64 vcc, vcc, s[42:43]
    s_or_b64 vcc, vcc, s[68:69]
    s_or_b64 vcc, vcc, s[70:71]
    s_or_b64 vcc, vcc, s[80:81]
    s_or_b64 vcc, vcc, s[82:83]
    s_or_b64 vcc, vcc, s[96:97]
    s_sub_u32 s87, s87, 1
    s_cmp_eq_u32 s87, 0
    s_cbranch_scc1 L_pollC_x
    s_cbranch_vccnz L_pollC
L_pollC_x:
    s_nop 4
    v_pk_add_f32 v[8:9], v[8:9], v[40:41]
    v_pk_add_f32 v[10:11], v[10:11], v[42:43]
    v_pk_add_f32 v[12:13], v[12:13], v[44:45]
    v_pk_add_f32 v[14:15], v[14:15], v[46:47]
    v_pk_add_f32 v[16:17], v[16:17], v[48:49]
    v_pk_add_f32 v[18:19], v[18:19], v[50:51]
    v_pk_add_f32 v[20:21], v[20:21], v[52:53]
    v_pk_add_f32 v[22:23], v[22:23], v[54:55]
    v_pk_add_f32 v[24:25], v[24:25], v[56:57]
    v_pk_add_f32 v[26:27], v[26:27], v[58:59]
    v_pk_add_f32 v[28:29], v[28:29], v[60:61]
    v_pk_add_f32 v[30:31], v[30:31], v[62:63]
    v_pk_add_f32 v[32:33], v[32:33], v[64:65]
    v_pk_add_f32 v[34:35], v[34:35], v[66:67]
    v_pk_add_f32 v[36:37], v[36:37], v[68:69]
    v_pk_add_f32 v[38:39], v[38:39], v[70:71]
    v_pk_add_f32 v[8:9], v[8:9], v[24:25]
    v_pk_add_f32 v[10:11], v[10:11], v[26:27]
    v_pk_add_f32 v[12:13], v[12:13], v[28:29]
    v_pk_add_f32 v[14:15], v[14:15], v[30:31]
    v_pk_add_f32 v[16:17], v[16:17], v[32:33]
    v_pk_add_f32 v[18:19], v[18:19], v[34:35]
    v_pk_add_f32 v[20:21], v[20:21], v[36:37]
    v_pk_add_f32 v[22:23], v[22:23], v[38:39]
    v_pk_add_f32 v[8:9], v[8:9], v[16:17]
    v_pk_add_f32 v[10:11], v[10:11], v[18:19]
    v_pk_add_f32 v[12:13], v[12:13], v[20:21]
    v_pk_add_f32 v[14:15], v[14:15], v[22:23]
    v_pk_add_f32 v[8:9], v[8:9], v[12:13]
    v_pk_add_f32 v[10:11], v[10:11], v[14:15]
    v_lshlrev_b32 v160, 16, v136
    v_and_b32 v161, 0xffff0000, v136
    v_lshlrev_b32 v162, 16, v137
    v_and_b32 v163, 0xffff0000, v137
    v_cvt_pk_bf16_f32 v8, v8, v8
    v_cvt_pk_bf16_f32 v9, v9, v9
    v_cvt_pk_bf16_f32 v10, v10, v10
    v_cvt_pk_bf16_f32 v11, v11, v11
    v_lshlrev_b32 v8, 16, v8
    v_lshlrev_b32 v9, 16, v9
    v_lshlrev_b32 v10, 16, v10
    v_lshlrev_b32 v11, 16, v11
    v_add_f32 v8, v8, v160
    v_add_f32 v9, v9, v161
    v_add_f32 v10, v10, v162
    v_add_f32 v11, v11, v163
    v_cvt_pk_bf16_f32 v12, v8, v9
    v_cvt_pk_bf16_f32 v13, v10, v11
    v_lshlrev_b32 v8, 16, v12
    v_and_b32 v9, 0xffff0000, v12
    v_lshlrev_b32 v10, 16, v13
    v_and_b32 v11, 0xffff0000, v13
    v_lshlrev_b32 v7, 4, v0
    v_lshlrev_b32 v6, 3, v0
    v_cmp_gt_u32 vcc, 224, v0
    s_nop 0
    s_and_saveexec_b64 s[78:79], vcc
    ds_write_b128 v7, v[8:11] offset:5376
    ds_write_b64 v6, v[12:13] offset:8960
    s_mov_b64 exec, -1
L_C_join:
    s_nop 4
    s_waitcnt lgkmcnt(0)
    s_barrier
    s_cmp_lg_u32 s90, 1
    s_cbranch_scc1 L_C_done
    v_and_b32 v6, 15, v1
    v_min_u32 v6, 2, v6
    v_mul_u32_u24 v6, 896, v6
    v_lshrrev_b32 v5, 4, v1
    v_lshl_add_u32 v6, v5, 4, v6
    ds_read_b128 v[64:67], v6 offset:8960
    ds_read_b128 v[68:71], v6 offset:9024
    ds_read_b128 v[72:75], v6 offset:9088
    ds_read_b128 v[76:79], v6 offset:9152
    ds_read_b128 v[80:83], v6 offset:9216
    ds_read_b128 v[84:87], v6 offset:9280
    ds_read_b128 v[88:91], v6 offset:9344
    ds_read_b128 v[124:127], v6 offset:9408
    ds_read_b128 v[128:131], v6 offset:9472
    ds_read_b128 v[132:135], v6 offset:9536
    ds_read_b128 v[136:139], v6 offset:9600
    ds_read_b128 v[140:143], v6 offset:9664
    ds_read_b128 v[144:147], v6 offset:9728
    ds_read_b128 v[148:151], v6 offset:9792
    v_mov_b32 v152, 0
    v_mov_b32 v153, 0
    v_mov_b32 v154, 0
    v_mov_b32 v155, 0
    v_mov_b32 v156, 0
    v_mov_b32 v157, 0
    v_mov_b32 v158, 0
    v_mov_b32 v159, 0
    s_waitcnt lgkmcnt(7)
    s_nop 0
    v_mfma_f32_16x16x32_bf16 v[156:159], v[64:67], v[64:67], v[156:159]
    v_mfma_f32_16x16x32_bf16 v[152:155], v[64:67], v[8:11], v[152:155]
    v_mfma_f32_16x16x32_bf16 v[156:159], v[68:71], v[68:71], v[156:159]
    v_mfma_f32_16x16x32_bf16 v[152:155], v[68:71], v[12:15], v[152:155]
    v_mfma_f32_16x16x32_bf16 v[156:159], v[72:75], v[72:75], v[156:159]
    v_mfma_f32_16x16x32_bf16 v[152:155], v[72:75], v[16:19], v[152:155]
    v_mfma_f32_16x16x32_bf16 v[156:159], v[76:79], v[76:79], v[156:159]
    v_mfma_f32_16x16x32_bf16 v[152:155], v[76:79], v[20:23], v[152:155]
    v_mfma_f32_16x16x32_bf16 v[156:159], v[80:83], v[80:83], v[156:159]
    v_mfma_f32_16x16x32_bf16 v[152:155], v[80:83], v[24:27], v[152:155]
    v_mfma_f32_16x16x32_bf16 v[156:159], v[84:87], v[84:87], v[156:159]
    v_mfma_f32_16x16x32_bf16 v[152:155], v[84:87], v[28:31], v[152:155]
    v_mfma_f32_16x16x32_bf16 v[156:159], v[88:91], v[88:91], v[156:159]
    v_mfma_f32_16x16x32_bf16 v[152:155], v[88:91], v[32:35], v[152:155]
    s_waitcnt lgkmcnt(0)
    v_mfma_f32_16x16x32_bf16 v[156:159], v[124:127], v[124:127], v[156:159]
    v_mfma_f32_16x16x32_bf16 v[156:159], v[128:131], v[128:131], v[156:159]
    v_mfma_f32_16x16x32_bf16 v[156:159], v[132:135], v[132:135], v[156:159]
    v_mfma_f32_16x16x32_bf16 v[156:159], v[136:139], v[136:139], v[156:159]
    v_mfma_f32_16x16x32_bf16 v[156:159], v[140:143], v[140:143], v[156:159]
    v_mfma_f32_16x16x32_bf16 v[156:159], v[144:147], v[144:147], v[156:159]
    v_mfma_f32_16x16x32_bf16 v[156:159], v[148:151], v[148:151], v[156:159]
    v_mfma_f32_16x16x32_bf16 v[152:155], v[124:127], v[36:39], v[152:155]
    v_mfma_f32_16x16x32_bf16 v[152:155], v[128:131], v[40:43], v[152:155]
    v_mfma_f32_16x16x32_bf16 v[152:155], v[132:135], v[44:47], v[152:155]
    v_mfma_f32_16x16x32_bf16 v[152:155], v[136:139], v[48:51], v[152:155]
    v_mfma_f32_16x16x32_bf16 v[152:155], v[140:143], v[52:55], v[152:155]
    v_mfma_f32_16x16x32_bf16 v[152:155], v[144:147], v[56:59], v[152:155]
    v_mfma_f32_16x16x32_bf16 v[152:155], v[148:151], v[60:63], v[152:155]
    s_mov_b32 s78, 0x3b124925
    v_readlane_b32 s16, v156, 0
    v_readlane_b32 s18, v158, 0
    v_readlane_b32 s17, v157, 1
    v_readlane_b32 s19, v158, 1
    v_mov_b32 v64, s18
    v_mov_b32 v66, s16
    v_mov_b32 v65, s19
    v_mov_b32 v67, s17
    v_mul_f32 v64, s78, v64
    v_mul_f32 v66, s78, v66
    v_mul_f32 v65, s78, v65
    v_mul_f32 v67, s78, v67
    v_fma_f32 v66, -v64, v64, v66
    v_fma_f32 v67, -v65, v65, v67
    v_max_f32 v66, 0, v66
    v_max_f32 v67, 0, v67
    v_cvt_pk_bf16_f32 v66, v66, v66
    v_cvt_pk_bf16_f32 v67, v67, v67
    v_cvt_pk_bf16_f32 v64, v64, v64
    v_cvt_pk_bf16_f32 v65, v65, v65
    v_lshlrev_b32 v66, 16, v66
    v_lshlrev_b32 v67, 16, v67
    v_lshlrev_b32 v64, 16, v64
    v_lshlrev_b32 v65, 16, v65
    v_add_f32 v66, 0x3727c5ac, v66
    v_add_f32 v67, 0x3727c5ac, v67
    v_cvt_pk_bf16_f32 v66, v66, v66
    v_cvt_pk_bf16_f32 v67, v67, v67
    v_lshlrev_b32 v66, 16, v66
    v_lshlrev_b32 v67, 16, v67
    v_sqrt_f32 v66, v66
    v_sqrt_f32 v67, v67
    v_cvt_pk_bf16_f32 v66, v66, v66
    v_cvt_pk_bf16_f32 v67, v67, v67
    v_lshlrev_b32 v66, 16, v66
    v_lshlrev_b32 v67, 16, v67
    v_rcp_f32 v66, v66
    v_rcp_f32 v67, v67
    v_fma_f32 v68, -v64, v154, v152
    v_fma_f32 v69, -v65, v154, v153
    v_mul_f32 v68, v68, v66
    v_mul_f32 v69, v69, v67
    v_cvt_pk_bf16_f32 v68, v68, v68
    v_cvt_pk_bf16_f32 v69, v69, v69
    v_lshlrev_b32 v68, 16, v68
    v_lshlrev_b32 v69, 16, v69
    v_mul_f32 v70, 0xbfb8aa3b, v68
    v_mul_f32 v71, 0xbfb8aa3b, v69
    v_exp_f32 v70, v70
    v_exp_f32 v71, v71
    v_add_f32 v70, 1.0, v70
    v_add_f32 v71, 1.0, v71
    v_rcp_f32 v70, v70
    v_rcp_f32 v71, v71
    v_mul_f32 v68, v68, v70
    v_mul_f32 v69, v69, v71
    s_nop 0
    v_mov_b32_dpp v70, v68 quad_perm:[1,0,3,2] row_mask:0xf bank_mask:0xf
    v_mov_b32_dpp v71, v69 quad_perm:[1,0,3,2] row_mask:0xf bank_mask:0xf
    v_cvt_pk_bf16_f32 v68, v68, v70
    v_cvt_pk_bf16_f32 v69, v69, v71
    v_and_b32 v6, 15, v1
    v_lshlrev_b32 v6, 1, v6
    s_lshl_b32 s84, s79, 5
    v_add_u32 v6, s84, v6
    s_mov_b64 exec, 0x5555
    ds_write_b32 v6, v68 offset:3328
    ds_write_b32 v6, v69 offset:3456
    s_mov_b64 exec, -1
L_C_done:
    s_nop 4
    s_waitcnt vmcnt(0) lgkmcnt(0)
    s_barrier
    s_lshl_b32 s84, s3, 5
    s_add_u32 s84, s84, 70656
    v_add_u32 v7, s84, v167
    ds_read_b64_tr_b16 v[92:93], v7 offset:0
    ds_read_b64_tr_b16 v[94:95], v7 offset:3584
    ds_read_b64_tr_b16 v[96:97], v7 offset:28672
    ds_read_b64_tr_b16 v[98:99], v7 offset:32256
    ds_read_b64_tr_b16 v[100:101], v7 offset:256
    ds_read_b64_tr_b16 v[102:103], v7 offset:3840
    ds_read_b64_tr_b16 v[104:105], v7 offset:28928
    ds_read_b64_tr_b16 v[106:107], v7 offset:32512
    ds_read_b64_tr_b16 v[108:109], v7 offset:512
    ds_read_b64_tr_b16 v[110:111], v7 offset:4096
    ds_read_b64_tr_b16 v[112:113], v7 offset:29184
    ds_read_b64_tr_b16 v[114:115], v7 offset:32768
    ds_read_b64_tr_b16 v[116:117], v7 offset:768
    ds_read_b64_tr_b16 v[118:119], v7 offset:4352
    ds_read_b64_tr_b16 v[120:121], v7 offset:29440
    ds_read_b64_tr_b16 v[122:123], v7 offset:33024
    v_and_b32 v6, 15, v1
    v_min_u32 v7, 1, v6
    v_lshlrev_b32 v7, 7, v7
    v_lshrrev_b32 v5, 4, v1
    v_lshl_add_u32 v7, v5, 4, v7
    ds_read_b128 v[8:11], v7 offset:3328
    ds_read_b128 v[12:15], v7 offset:3392
    v_mov_b32 v16, 0
    v_mov_b32 v17, 0
    v_mov_b32 v18, 0
    v_mov_b32 v19, 0
    v_mov_b32 v20, 0
    v_mov_b32 v21, 0
    v_mov_b32 v22, 0
    v_mov_b32 v23, 0
    v_mov_b32 v24, 0
    v_mov_b32 v25, 0
    v_mov_b32 v26, 0
    v_mov_b32 v27, 0
    v_mov_b32 v28, 0
    v_mov_b32 v29, 0
    v_mov_b32 v30, 0
    v_mov_b32 v31, 0
    v_mul_u32_u24 v6, 1792, v6
    v_lshl_add_u32 v6, v5, 4, v6
    s_mul_i32 s78, s77, 3584
    s_lshl_b32 s84, s3, 6
    s_add_u32 s78, s78, s84
    s_add_u32 s78, s78, 1179648
    s_waitcnt lgkmcnt(0)
    v_mfma_f32_16x16x32_bf16 v[16:19], v[92:95], v[8:11], v[16:19]
    v_mfma_f32_16x16x32_bf16 v[20:23], v[100:103], v[8:11], v[20:23]
    v_mfma_f32_16x16x32_bf16 v[24:27], v[108:111], v[8:11], v[24:27]
    v_mfma_f32_16x16x32_bf16 v[28:31], v[116:119], v[8:11], v[28:31]
    v_mfma_f32_16x16x32_bf16 v[16:19], v[96:99], v[12:15], v[16:19]
    v_mfma_f32_16x16x32_bf16 v[20:23], v[104:107], v[12:15], v[20:23]
    v_mfma_f32_16x16x32_bf16 v[24:27], v[112:115], v[12:15], v[24:27]
    v_mfma_f32_16x16x32_bf16 v[28:31], v[120:123], v[12:15], v[28:31]
    s_mov_b32 exec_lo, 0x00030003
    s_mov_b32 exec_hi, 0x00030003
    s_nop 2
    buffer_store_dwordx4 v[16:19], v6, s[36:39], s78 offen offset:0 sc1
    buffer_store_dwordx4 v[20:23], v6, s[36:39], s78 offen offset:512 sc1
    buffer_store_dwordx4 v[24:27], v6, s[36:39], s78 offen offset:1024 sc1
    s_cmp_ge_u32 s3, 4
    s_cbranch_scc1 L_D_skip
    buffer_store_dwordx4 v[28:31], v6, s[36:39], s78 offen offset:1536 sc1
L_D_skip:
    s_nop 4
    s_mov_b64 exec, -1
    s_cmp_lg_u32 s100, 2
    s_cbranch_scc1 L_fin
    s_cmp_lg_u32 s3, 0
    s_cbranch_scc1 L_fin
    v_lshrrev_b32 v5, 5, v1
    v_mul_u32_u24 v7, 1792, v5
    v_and_b32 v6, 31, v1
    v_lshl_add_u32 v7, v6, 2, v7
    s_lshl_b32 s78, s77, 7
    s_add_u32 s78, s78, 1179648
    v_mul_u32_u24 v5, 448, v5
    v_add_u32 v6, v6, v5
    s_lshl_b32 s84, s77, 5
    v_add_u32 v6, s84, v6
    v_lshlrev_b32 v5, 2, v6
    ds_read_b32 v40, v5 offset:5376
    v_lshlrev_b32 v6, 1, v6
L_pollR:
    s_nop 4
    s_mov_b32 s84, s78
    buffer_load_dword v8, v7, s[36:39], s84 offen sc1
    s_add_u32 s84, s84, 3584
    buffer_load_dword v9, v7, s[36:39], s84 offen sc1
    s_add_u32 s84, s84, 3584
    buffer_load_dword v10, v7, s[36:39], s84 offen sc1
    s_add_u32 s84, s84, 3584
    buffer_load_dword v11, v7, s[36:39], s84 offen sc1
    s_add_u32 s84, s84, 3584
    buffer_load_dword v12, v7, s[36:39], s84 offen sc1
    s_add_u32 s84, s84, 3584
    buffer_load_dword v13, v7, s[36:39], s84 offen sc1
    s_add_u32 s84, s84, 3584
    buffer_load_dword v14, v7, s[36:39], s84 offen sc1
    s_add_u32 s84, s84, 3584
    buffer_load_dword v15, v7, s[36:39], s84 offen sc1
    s_add_u32 s84, s84, 3584
    buffer_load_dword v16, v7, s[36:39], s84 offen sc1
    s_add_u32 s84, s84, 3584
    buffer_load_dword v17, v7, s[36:39], s84 offen sc1
    s_add_u32 s84, s84, 3584
    buffer_load_dword v18, v7, s[36:39], s84 offen sc1
    s_add_u32 s84, s84, 3584
    buffer_load_dword v19, v7, s[36:39], s84 offen sc1
    s_add_u32 s84, s84, 3584
    buffer_load_dword v20, v7, s[36:39], s84 offen sc1
    s_add_u32 s84, s84, 3584
    buffer_load_dword v21, v7, s[36:39], s84 offen sc1
    s_add_u32 s84, s84, 3584
    buffer_load_dword v22, v7, s[36:39], s84 offen sc1
    s_add_u32 s84, s84, 3584
    buffer_load_dword v23, v7, s[36:39], s84 offen sc1
    s_add_u32 s84, s84, 3584
    buffer_load_dword v24, v7, s[36:39], s84 offen sc1
    s_add_u32 s84, s84, 3584
    buffer_load_dword v25, v7, s[36:39], s84 offen sc1
    s_add_u32 s84, s84, 3584
    buffer_load_dword v26, v7, s[36:39], s84 offen sc1
    s_add_u32 s84, s84, 3584
    buffer_load_dword v27, v7, s[36:39], s84 offen sc1
    s_add_u32 s84, s84, 3584
    buffer_load_dword v28, v7, s[36:39], s84 offen sc1
    s_add_u32 s84, s84, 3584
    buffer_load_dword v29, v7, s[36:39], s84 offen sc1
    s_add_u32 s84, s84, 3584
    buffer_load_dword v30, v7, s[36:39], s84 offen sc1
    s_add_u32 s84, s84, 3584
    buffer_load_dword v31, v7, s[36:39], s84 offen sc1
    s_add_u32 s84, s84, 3584
    buffer_load_dword v32, v7, s[36:39], s84 offen sc1
    s_add_u32 s84, s84, 3584
    buffer_load_dword v33, v7, s[36:39], s84 offen sc1
    s_add_u32 s84, s84, 3584
    buffer_load_dword v34, v7, s[36:39], s84 offen sc1
    s_add_u32 s84, s84, 3584
    buffer_load_dword v35, v7, s[36:39], s84 offen sc1
    s_waitcnt vmcnt(0)
    v_max_u32 v160, v8, v9
    v_max3_u32 v160, v160, v10, v11
    v_max3_u32 v160, v160, v12, v13
    v_max3_u32 v160, v160, v14, v15
    v_max3_u32 v160, v160, v16, v17
    v_max3_u32 v160, v160, v18, v19
    v_max3_u32 v160, v160, v20, v21
    v_max3_u32 v160, v160, v22, v23
    v_max3_u32 v160, v160, v24, v25
    v_max3_u32 v160, v160, v26, v27
    v_max3_u32 v160, v160, v28, v29
    v_max3_u32 v160, v160, v30, v31
    v_max3_u32 v160, v160, v32, v33
    v_max3_u32 v160, v160, v34, v35
    v_cmp_eq_u32 vcc, -1, v160
    s_sub_u32 s87, s87, 1
    s_cmp_eq_u32 s87, 0
    s_cbranch_scc1 L_pollR_x
    s_mov_b64 exec, vcc
    s_cbranch_vccnz L_pollR
L_pollR_x:
    s_nop 4
    s_mov_b64 exec, -1
    v_add_f32 v8, v8, v9
    v_add_f32 v10, v10, v11
    v_add_f32 v12, v12, v13
    v_add_f32 v14, v14, v15
    v_add_f32 v16, v16, v17
    v_add_f32 v18, v18, v19
    v_add_f32 v20, v20, v21
    v_add_f32 v22, v22, v23
    v_add_f32 v24, v24, v25
    v_add_f32 v26, v26, v27
    v_add_f32 v28, v28, v29
    v_add_f32 v30, v30, v31
    v_add_f32 v32, v32, v33
    v_add_f32 v34, v34, v35
    v_add_f32 v8, v8, v10
    v_add_f32 v12, v12, v14
    v_add_f32 v16, v16, v18
    v_add_f32 v20, v20, v22
    v_add_f32 v24, v24, v26
    v_add_f32 v28, v28, v30
    v_add_f32 v32, v32, v34
    v_add_f32 v8, v8, v12
    v_add_f32 v16, v16, v20
    v_add_f32 v24, v24, v28
    v_add_f32 v8, v8, v16
    v_add_f32 v24, v24, v32
    v_add_f32 v8, v8, v24
    s_waitcnt lgkmcnt(0)
    v_cvt_pk_bf16_f32 v8, v8, v8
    v_lshlrev_b32 v8, 16, v8
    v_add_f32 v8, v8, v40
    v_cvt_pk_bf16_f32 v8, v8, v8
    buffer_store_short v8, v6, s[60:63], 0 offen
L_fin:
    s_nop 4
L_end:
    s_endpgm
L_aux:
    s_nop 4
    v_mov_b32 v143, 0
    buffer_load_dword v142, v143, s[64:67], 0 offen sc1
    v_lshlrev_b32 v2, 4, v1
    v_mov_b32 v3, 0x10000
    v_cmp_gt_u32 vcc, 56, v1
    s_nop 1
    v_cndmask_b32 v2, v3, v2, vcc
    buffer_load_dwordx4 v[8:11], v2, s[56:59], 0 offen
    buffer_load_dwordx4 v[12:15], v2, s[56:59], 0 offen offset:896
    s_lshl_b32 s78, s72, 4
    s_or_b32 s78, s78, s74
    s_and_b32 s79, s78, 7
    s_lshr_b32 s78, s78, 3
    s_mul_i32 s84, s78, 917504
    s_lshl_b32 s85, s73, 10
    s_add_u32 s84, s84, s85
    s_lshl_b32 s85, s79, 7
    s_add_u32 s84, s84, s85
    v_lshrrev_b32 v3, 3, v1
    v_lshlrev_b32 v3, 13, v3
    v_and_b32 v4, 7, v1
    v_lshl_add_u32 v3, v4, 4, v3
    buffer_load_dwordx4 v[16:19], v3, s[40:43], s84 offen nt
    s_add_u32 s84, s84, 65536
    buffer_load_dwordx4 v[20:23], v3, s[40:43], s84 offen nt
    s_add_u32 s84, s84, 65536
    buffer_load_dwordx4 v[24:27], v3, s[40:43], s84 offen nt
    s_add_u32 s84, s84, 65536
    buffer_load_dwordx4 v[28:31], v3, s[40:43], s84 offen nt
    s_add_u32 s84, s84, 65536
    buffer_load_dwordx4 v[32:35], v3, s[40:43], s84 offen nt
    s_add_u32 s84, s84, 65536
    buffer_load_dwordx4 v[36:39], v3, s[40:43], s84 offen nt
    s_add_u32 s84, s84, 65536
    buffer_load_dwordx4 v[40:43], v3, s[40:43], s84 offen nt
    s_add_u32 s84, s84, 65536
    buffer_load_dwordx4 v[44:47], v3, s[40:43], s84 offen nt
    s_add_u32 s84, s84, 65536
    buffer_load_dwordx4 v[48:51], v3, s[40:43], s84 offen nt
    s_add_u32 s84, s84, 65536
    buffer_load_dwordx4 v[52:55], v3, s[40:43], s84 offen nt
    s_add_u32 s84, s84, 65536
    buffer_load_dwordx4 v[56:59], v3, s[40:43], s84 offen nt
    s_add_u32 s84, s84, 65536
    buffer_load_dwordx4 v[60:63], v3, s[40:43], s84 offen nt
    s_add_u32 s84, s84, 65536
    buffer_load_dwordx4 v[64:67], v3, s[40:43], s84 offen nt
    s_add_u32 s84, s84, 65536
    buffer_load_dwordx4 v[68:71], v3, s[40:43], s84 offen nt
    v_mov_b32 v132, -1
    v_mov_b32 v133, -1
    v_mov_b32 v134, -1
    v_mov_b32 v135, -1
    s_lshl_b32 s84, s72, 4
    s_lshl_b32 s85, s73, 1
    s_add_u32 s84, s84, s85
    s_lshl_b32 s85, s84, 13
    s_lshl_b32 s26, s74, 6
    s_add_u32 s85, s85, s26
    s_add_u32 s85, s85, 524288
    v_lshrrev_b32 v5, 5, v1
    v_lshrrev_b32 v6, 2, v1
    v_lshlrev_b32 v6, 10, v6
    v_and_b32 v7, 3, v1
    v_lshl_add_u32 v6, v7, 4, v6
    buffer_store_dwordx4 v[132:135], v6, s[36:39], s85 offen
    s_add_u32 s85, s85, 327680
    buffer_store_dwordx4 v[132:135], v6, s[36:39], s85 offen sc1
    s_lshl_b32 s85, s84, 4
    s_add_u32 s85, s85, s74
    s_lshl_b32 s85, s85, 3
    s_add_u32 s85, s85, 786432
    v_lshlrev_b32 v6, 7, v1
    s_mov_b64 exec, 3
    buffer_store_dwordx2 v[132:133], v6, s[36:39], s85 offen
    s_add_u32 s85, s85, 327680
    buffer_store_dwordx2 v[132:133], v6, s[36:39], s85 offen sc1
    s_mov_b64 exec, -1
    v_and_b32 v7, 31, v1
    v_mul_u32_u24 v6, 1792, v5
    v_lshl_add_u32 v6, v7, 2, v6
    s_cmp_ge_u32 s91, 28
    s_cbranch_scc1 L_aux_noB
    s_mul_i32 s84, s75, 3584
    s_lshl_b32 s85, s76, 7
    s_add_u32 s84, s84, s85
    s_add_u32 s84, s84, 1122304
    buffer_store_dword v132, v6, s[36:39], s84 offen sc1
L_aux_noB:
    s_nop 4
    s_cmp_eq_u32 s100, 0
    s_cbranch_scc1 L_aux_noC
    v_lshlrev_b32 v6, 4, v1
    s_mul_i32 s84, s77, 3584
    s_add_u32 s84, s84, 1179648
    buffer_store_dwordx4 v[132:135], v6, s[36:39], s84 offen offset:0 sc1
    buffer_store_dwordx4 v[132:135], v6, s[36:39], s84 offen offset:1024 sc1
    buffer_store_dwordx4 v[132:135], v6, s[36:39], s84 offen offset:2048 sc1
    s_mov_b64 exec, 0xffffffff
    buffer_store_dwordx4 v[132:135], v6, s[36:39], s84 offen offset:3072 sc1
    s_mov_b64 exec, -1
L_aux_noC:
    s_nop 4
    s_waitcnt vmcnt(18)
    v_readfirstlane_b32 s89, v142
    buffer_load_dword v142, v143, s[64:67], 0 offen sc1
    v_lshlrev_b32 v100, 16, v8
    v_and_b32 v102, 0xffff0000, v8
    v_lshlrev_b32 v101, 16, v12
    v_and_b32 v103, 0xffff0000, v12
    v_lshlrev_b32 v104, 16, v9
    v_and_b32 v106, 0xffff0000, v9
    v_lshlrev_b32 v105, 16, v13
    v_and_b32 v107, 0xffff0000, v13
    v_lshlrev_b32 v108, 16, v10
    v_and_b32 v110, 0xffff0000, v10
    v_lshlrev_b32 v109, 16, v14
    v_and_b32 v111, 0xffff0000, v14
    v_lshlrev_b32 v112, 16, v11
    v_and_b32 v114, 0xffff0000, v11
    v_lshlrev_b32 v113, 16, v15
    v_and_b32 v115, 0xffff0000, v15
    v_add_f32 v136, v100, v102
    v_add_f32 v137, v101, v103
    v_add_f32 v136, v136, v104
    v_add_f32 v137, v137, v105
    v_add_f32 v136, v136, v106
    v_add_f32 v137, v137, v107
    v_add_f32 v136, v136, v108
    v_add_f32 v137, v137, v109
    v_add_f32 v136, v136, v110
    v_add_f32 v137, v137, v111
    v_add_f32 v136, v136, v112
    v_add_f32 v137, v137, v113
    v_add_f32 v136, v136, v114
    v_add_f32 v137, v137, v115
    s_nop 0
    v_add_f32_dpp v136, v136, v136 quad_perm:[1,0,3,2] row_mask:0xf bank_mask:0xf
    v_add_f32_dpp v137, v137, v137 quad_perm:[1,0,3,2] row_mask:0xf bank_mask:0xf
    s_nop 0
    v_add_f32_dpp v136, v136, v136 quad_perm:[2,3,0,1] row_mask:0xf bank_mask:0xf
    v_add_f32_dpp v137, v137, v137 quad_perm:[2,3,0,1] row_mask:0xf bank_mask:0xf
    s_nop 0
    v_add_f32_dpp v136, v136, v136 row_half_mirror row_mask:0xf bank_mask:0xf
    v_add_f32_dpp v137, v137, v137 row_half_mirror row_mask:0xf bank_mask:0xf
    s_nop 0
    v_add_f32_dpp v136, v136, v136 row_mirror row_mask:0xf bank_mask:0xf
    v_add_f32_dpp v137, v137, v137 row_mirror row_mask:0xf bank_mask:0xf
    v_mov_b32 v140, v136
    v_mov_b32 v141, v137
    s_nop 0
    v_permlane16_swap_b32 v136, v140
    v_permlane16_swap_b32 v137, v141
    v_add_f32 v136, v136, v140
    v_add_f32 v137, v137, v141
    v_mov_b32 v140, v136
    v_mov_b32 v141, v137
    s_nop 0
    v_permlane32_swap_b32 v136, v140
    v_permlane32_swap_b32 v137, v141
    v_add_f32 v136, v136, v140
    v_add_f32 v137, v137, v141
    s_mov_b32 s84, 0x3b124925
    v_mul_f32 v136, s84, v136
    v_mul_f32 v137, s84, v137
    v_mov_b32 v138, 0
    v_mov_b32 v139, 0
    v_sub_f32 v140, v100, v136
    v_sub_f32 v141, v101, v137
    v_fmac_f32 v138, v140, v140
    v_fmac_f32 v139, v141, v141
    v_sub_f32 v140, v102, v136
    v_sub_f32 v141, v103, v137
    v_fmac_f32 v138, v140, v140
    v_fmac_f32 v139, v141, v141
    v_sub_f32 v140, v104, v136
    v_sub_f32 v141, v105, v137
    v_fmac_f32 v138, v140, v140
    v_fmac_f32 v139, v141, v141
    v_sub_f32 v140, v106, v136
    v_sub_f32 v141, v107, v137
    v_fmac_f32 v138, v140, v140
    v_fmac_f32 v139, v141, v141
    v_sub_f32 v140, v108, v136
    v_sub_f32 v141, v109, v137
    v_fmac_f32 v138, v140, v140
    v_fmac_f32 v139, v141, v141
    v_sub_f32 v140, v110, v136
    v_sub_f32 v141, v111, v137
    v_fmac_f32 v138, v140, v140
    v_fmac_f32 v139, v141, v141
    v_sub_f32 v140, v112, v136
    v_sub_f32 v141, v113, v137
    v_fmac_f32 v138, v140, v140
    v_fmac_f32 v139, v141, v141
    v_sub_f32 v140, v114, v136
    v_sub_f32 v141, v115, v137
    v_fmac_f32 v138, v140, v140
    v_fmac_f32 v139, v141, v141
    v_cmp_gt_u32 vcc, 56, v1
    s_nop 1
    v_cndmask_b32 v138, 0, v138, vcc
    v_cndmask_b32 v139, 0, v139, vcc
    s_nop 0
    v_add_f32_dpp v138, v138, v138 quad_perm:[1,0,3,2] row_mask:0xf bank_mask:0xf
    v_add_f32_dpp v139, v139, v139 quad_perm:[1,0,3,2] row_mask:0xf bank_mask:0xf
    s_nop 0
    v_add_f32_dpp v138, v138, v138 quad_perm:[2,3,0,1] row_mask:0xf bank_mask:0xf
    v_add_f32_dpp v139, v139, v139 quad_perm:[2,3,0,1] row_mask:0xf bank_mask:0xf
    s_nop 0
    v_add_f32_dpp v138, v138, v138 row_half_mirror row_mask:0xf bank_mask:0xf
    v_add_f32_dpp v139, v139, v139 row_half_mirror row_mask:0xf bank_mask:0xf
    s_nop 0
    v_add_f32_dpp v138, v138, v138 row_mirror row_mask:0xf bank_mask:0xf
    v_add_f32_dpp v139, v139, v139 row_mirror row_mask:0xf bank_mask:0xf
    v_mov_b32 v140, v138
    v_mov_b32 v141, v139
    s_nop 0
    v_permlane16_swap_b32 v138, v140
    v_permlane16_swap_b32 v139, v141
    v_add_f32 v138, v138, v140
    v_add_f32 v139, v139, v141
    v_mov_b32 v140, v138
    v_mov_b32 v141, v139
    s_nop 0
    v_permlane32_swap_b32 v138, v140
    v_permlane32_swap_b32 v139, v141
    v_add_f32 v138, v138, v140
    v_add_f32 v139, v139, v141
    v_mul_f32 v138, s84, v138
    v_mul_f32 v139, s84, v139
    buffer_load_dword v141, v143, s[64:67], 0 offen sc1
    v_cvt_pk_bf16_f32 v138, v138, v138
    v_cvt_pk_bf16_f32 v139, v139, v139
    v_cvt_pk_bf16_f32 v136, v136, v136
    v_cvt_pk_bf16_f32 v137, v137, v137
    v_lshlrev_b32 v138, 16, v138
    v_lshlrev_b32 v139, 16, v139
    v_lshlrev_b32 v136, 16, v136
    v_lshlrev_b32 v137, 16, v137
    v_add_f32 v138, 0x3727c5ac, v138
    v_add_f32 v139, 0x3727c5ac, v139
    v_cvt_pk_bf16_f32 v138, v138, v138
    v_cvt_pk_bf16_f32 v139, v139, v139
    v_lshlrev_b32 v138, 16, v138
    v_lshlrev_b32 v139, 16, v139
    v_sqrt_f32 v138, v138
    v_sqrt_f32 v139, v139
    v_cvt_pk_bf16_f32 v138, v138, v138
    v_cvt_pk_bf16_f32 v139, v139, v139
    v_lshlrev_b32 v138, 16, v138
    v_lshlrev_b32 v139, 16, v139
    v_rcp_f32 v138, v138
    v_rcp_f32 v139, v139
    v_sub_f32 v100, v100, v136
    v_sub_f32 v101, v101, v137
    v_sub_f32 v102, v102, v136
    v_sub_f32 v103, v103, v137
    v_sub_f32 v104, v104, v136
    v_sub_f32 v105, v105, v137
    v_sub_f32 v106, v106, v136
    v_sub_f32 v107, v107, v137
    v_sub_f32 v108, v108, v136
    v_sub_f32 v109, v109, v137
    v_sub_f32 v110, v110, v136
    v_sub_f32 v111, v111, v137
    v_sub_f32 v112, v112, v136
    v_sub_f32 v113, v113, v137
    v_sub_f32 v114, v114, v136
    v_sub_f32 v115, v115, v137
    v_cvt_pk_bf16_f32 v100, v100, v100
    v_cvt_pk_bf16_f32 v101, v101, v101
    v_cvt_pk_bf16_f32 v102, v102, v102
    v_cvt_pk_bf16_f32 v103, v103, v103
    v_cvt_pk_bf16_f32 v104, v104, v104
    v_cvt_pk_bf16_f32 v105, v105, v105
    v_cvt_pk_bf16_f32 v106, v106, v106
    v_cvt_pk_bf16_f32 v107, v107, v107
    v_cvt_pk_bf16_f32 v108, v108, v108
    v_cvt_pk_bf16_f32 v109, v109, v109
    v_cvt_pk_bf16_f32 v110, v110, v110
    v_cvt_pk_bf16_f32 v111, v111, v111
    v_cvt_pk_bf16_f32 v112, v112, v112
    v_cvt_pk_bf16_f32 v113, v113, v113
    v_cvt_pk_bf16_f32 v114, v114, v114
    v_cvt_pk_bf16_f32 v115, v115, v115
    v_lshlrev_b32 v100, 16, v100
    v_lshlrev_b32 v101, 16, v101
    v_lshlrev_b32 v102, 16, v102
    v_lshlrev_b32 v103, 16, v103
    v_lshlrev_b32 v104, 16, v104
    v_lshlrev_b32 v105, 16, v105
    v_lshlrev_b32 v106, 16, v106
    v_lshlrev_b32 v107, 16, v107
    v_lshlrev_b32 v108, 16, v108
    v_lshlrev_b32 v109, 16, v109
    v_lshlrev_b32 v110, 16, v110
    v_lshlrev_b32 v111, 16, v111
    v_lshlrev_b32 v112, 16, v112
    v_lshlrev_b32 v113, 16, v113
    v_lshlrev_b32 v114, 16, v114
    v_lshlrev_b32 v115, 16, v115
    v_mul_f32 v100, v100, v138
    v_mul_f32 v101, v101, v139
    v_mul_f32 v102, v102, v138
    v_mul_f32 v103, v103, v139
    v_mul_f32 v104, v104, v138
    v_mul_f32 v105, v105, v139
    v_mul_f32 v106, v106, v138
    v_mul_f32 v107, v107, v139
    v_mul_f32 v108, v108, v138
    v_mul_f32 v109, v109, v139
    v_mul_f32 v110, v110, v138
    v_mul_f32 v111, v111, v139
    v_mul_f32 v112, v112, v138
    v_mul_f32 v113, v113, v139
    v_mul_f32 v114, v114, v138
    v_mul_f32 v115, v115, v139
    v_cvt_pk_bf16_f32 v100, v100, v100
    v_cvt_pk_bf16_f32 v101, v101, v101
    v_cvt_pk_bf16_f32 v102, v102, v102
    v_cvt_pk_bf16_f32 v103, v103, v103
    v_cvt_pk_bf16_f32 v104, v104, v104
    v_cvt_pk_bf16_f32 v105, v105, v105
    v_cvt_pk_bf16_f32 v106, v106, v106
    v_cvt_pk_bf16_f32 v107, v107, v107
    v_cvt_pk_bf16_f32 v108, v108, v108
    v_cvt_pk_bf16_f32 v109, v109, v109
    v_cvt_pk_bf16_f32 v110, v110, v110
    v_cvt_pk_bf16_f32 v111, v111, v111
    v_cvt_pk_bf16_f32 v112, v112, v112
    v_cvt_pk_bf16_f32 v113, v113, v113
    v_cvt_pk_bf16_f32 v114, v114, v114
    v_cvt_pk_bf16_f32 v115, v115, v115
    v_lshlrev_b32 v100, 16, v100
    v_lshlrev_b32 v101, 16, v101
    v_lshlrev_b32 v102, 16, v102
    v_lshlrev_b32 v103, 16, v103
    v_lshlrev_b32 v104, 16, v104
    v_lshlrev_b32 v105, 16, v105
    v_lshlrev_b32 v106, 16, v106
    v_lshlrev_b32 v107, 16, v107
    v_lshlrev_b32 v108, 16, v108
    v_lshlrev_b32 v109, 16, v109
    v_lshlrev_b32 v110, 16, v110
    v_lshlrev_b32 v111, 16, v111
    v_lshlrev_b32 v112, 16, v112
    v_lshlrev_b32 v113, 16, v113
    v_lshlrev_b32 v114, 16, v114
    v_lshlrev_b32 v115, 16, v115
    v_lshlrev_b32 v5, 6, v1
    v_add_u32 v5, 128000, v5
    ds_write_b128 v5, v[100:103] offset:0
    ds_write_b128 v5, v[104:107] offset:16
    ds_write_b128 v5, v[108:111] offset:32
    ds_write_b128 v5, v[112:115] offset:48
    s_mul_i32 s84, s78, 896
    s_add_u32 s84, s84, 128000
    v_lshrrev_b32 v5, 3, v1
    v_lshlrev_b32 v5, 3, v5
    v_add_u32 v5, s84, v5
    s_waitcnt lgkmcnt(0)
    ds_read_b64 v[72:73], v5 offset:0
    ds_read_b64 v[74:75], v5 offset:64
    ds_read_b64 v[76:77], v5 offset:128
    ds_read_b64 v[78:79], v5 offset:192
    ds_read_b64 v[80:81], v5 offset:256
    ds_read_b64 v[82:83], v5 offset:320
    ds_read_b64 v[84:85], v5 offset:384
    ds_read_b64 v[86:87], v5 offset:448
    ds_read_b64 v[88:89], v5 offset:512
    ds_read_b64 v[90:91], v5 offset:576
    ds_read_b64 v[92:93], v5 offset:640
    ds_read_b64 v[94:95], v5 offset:704
    ds_read_b64 v[96:97], v5 offset:768
    ds_read_b64 v[98:99], v5 offset:832
    v_mov_b32 v116, 0
    v_mov_b32 v117, 0
    v_mov_b32 v118, 0
    v_mov_b32 v119, 0
    v_mov_b32 v120, 0
    v_mov_b32 v121, 0
    v_mov_b32 v122, 0
    v_mov_b32 v123, 0
    v_mov_b32 v124, 0
    v_mov_b32 v125, 0
    v_mov_b32 v126, 0
    v_mov_b32 v127, 0
    v_mov_b32 v128, 0
    v_mov_b32 v129, 0
    v_mov_b32 v130, 0
    v_mov_b32 v131, 0
    s_waitcnt vmcnt(0) lgkmcnt(0)
    buffer_load_dword v140, v143, s[64:67], 0 offen sc1
    v_lshlrev_b32 v132, 16, v16
    v_and_b32 v133, 0xffff0000, v16
    v_pk_fma_f32 v[116:117], v[132:133], v[72:73], v[116:117] op_sel:[0,0,0] op_sel_hi:[1,0,1]
    v_pk_fma_f32 v[124:125], v[132:133], v[72:73], v[124:125] op_sel:[0,1,0] op_sel_hi:[1,1,1]
    v_lshlrev_b32 v134, 16, v17
    v_and_b32 v135, 0xffff0000, v17
    v_pk_fma_f32 v[118:119], v[134:135], v[72:73], v[118:119] op_sel:[0,0,0] op_sel_hi:[1,0,1]
    v_pk_fma_f32 v[126:127], v[134:135], v[72:73], v[126:127] op_sel:[0,1,0] op_sel_hi:[1,1,1]
    v_lshlrev_b32 v132, 16, v18
    v_and_b32 v133, 0xffff0000, v18
    v_pk_fma_f32 v[120:121], v[132:133], v[72:73], v[120:121] op_sel:[0,0,0] op_sel_hi:[1,0,1]
    v_pk_fma_f32 v[128:129], v[132:133], v[72:73], v[128:129] op_sel:[0,1,0] op_sel_hi:[1,1,1]
    v_lshlrev_b32 v134, 16, v19
    v_and_b32 v135, 0xffff0000, v19
    v_pk_fma_f32 v[122:123], v[134:135], v[72:73], v[122:123] op_sel:[0,0,0] op_sel_hi:[1,0,1]
    v_pk_fma_f32 v[130:131], v[134:135], v[72:73], v[130:131] op_sel:[0,1,0] op_sel_hi:[1,1,1]
    v_lshlrev_b32 v132, 16, v20
    v_and_b32 v133, 0xffff0000, v20
    v_pk_fma_f32 v[116:117], v[132:133], v[74:75], v[116:117] op_sel:[0,0,0] op_sel_hi:[1,0,1]
    v_pk_fma_f32 v[124:125], v[132:133], v[74:75], v[124:125] op_sel:[0,1,0] op_sel_hi:[1,1,1]
    v_lshlrev_b32 v134, 16, v21
    v_and_b32 v135, 0xffff0000, v21
    v_pk_fma_f32 v[118:119], v[134:135], v[74:75], v[118:119] op_sel:[0,0,0] op_sel_hi:[1,0,1]
    v_pk_fma_f32 v[126:127], v[134:135], v[74:75], v[126:127] op_sel:[0,1,0] op_sel_hi:[1,1,1]
    v_lshlrev_b32 v132, 16, v22
    v_and_b32 v133, 0xffff0000, v22
    v_pk_fma_f32 v[120:121], v[132:133], v[74:75], v[120:121] op_sel:[0,0,0] op_sel_hi:[1,0,1]
    v_pk_fma_f32 v[128:129], v[132:133], v[74:75], v[128:129] op_sel:[0,1,0] op_sel_hi:[1,1,1]
    v_lshlrev_b32 v134, 16, v23
    v_and_b32 v135, 0xffff0000, v23
    v_pk_fma_f32 v[122:123], v[134:135], v[74:75], v[122:123] op_sel:[0,0,0] op_sel_hi:[1,0,1]
    v_pk_fma_f32 v[130:131], v[134:135], v[74:75], v[130:131] op_sel:[0,1,0] op_sel_hi:[1,1,1]
    v_lshlrev_b32 v132, 16, v24
    v_and_b32 v133, 0xffff0000, v24
    v_pk_fma_f32 v[116:117], v[132:133], v[76:77], v[116:117] op_sel:[0,0,0] op_sel_hi:[1,0,1]
    v_pk_fma_f32 v[124:125], v[132:133], v[76:77], v[124:125] op_sel:[0,1,0] op_sel_hi:[1,1,1]
    v_lshlrev_b32 v134, 16, v25
    v_and_b32 v135, 0xffff0000, v25
    v_pk_fma_f32 v[118:119], v[134:135], v[76:77], v[118:119] op_sel:[0,0,0] op_sel_hi:[1,0,1]
    v_pk_fma_f32 v[126:127], v[134:135], v[76:77], v[126:127] op_sel:[0,1,0] op_sel_hi:[1,1,1]
    v_lshlrev_b32 v132, 16, v26
    v_and_b32 v133, 0xffff0000, v26
    v_pk_fma_f32 v[120:121], v[132:133], v[76:77], v[120:121] op_sel:[0,0,0] op_sel_hi:[1,0,1]
    v_pk_fma_f32 v[128:129], v[132:133], v[76:77], v[128:129] op_sel:[0,1,0] op_sel_hi:[1,1,1]
    v_lshlrev_b32 v134, 16, v27
    v_and_b32 v135, 0xffff0000, v27
    v_pk_fma_f32 v[122:123], v[134:135], v[76:77], v[122:123] op_sel:[0,0,0] op_sel_hi:[1,0,1]
    v_pk_fma_f32 v[130:131], v[134:135], v[76:77], v[130:131] op_sel:[0,1,0] op_sel_hi:[1,1,1]
    v_lshlrev_b32 v132, 16, v28
    v_and_b32 v133, 0xffff0000, v28
    v_pk_fma_f32 v[116:117], v[132:133], v[78:79], v[116:117] op_sel:[0,0,0] op_sel_hi:[1,0,1]
    v_pk_fma_f32 v[124:125], v[132:133], v[78:79], v[124:125] op_sel:[0,1,0] op_sel_hi:[1,1,1]
    v_lshlrev_b32 v134, 16, v29
    v_and_b32 v135, 0xffff0000, v29
    v_pk_fma_f32 v[118:119], v[134:135], v[78:79], v[118:119] op_sel:[0,0,0] op_sel_hi:[1,0,1]
    v_pk_fma_f32 v[126:127], v[134:135], v[78:79], v[126:127] op_sel:[0,1,0] op_sel_hi:[1,1,1]
    v_lshlrev_b32 v132, 16, v30
    v_and_b32 v133, 0xffff0000, v30
    v_pk_fma_f32 v[120:121], v[132:133], v[78:79], v[120:121] op_sel:[0,0,0] op_sel_hi:[1,0,1]
    v_pk_fma_f32 v[128:129], v[132:133], v[78:79], v[128:129] op_sel:[0,1,0] op_sel_hi:[1,1,1]
    v_lshlrev_b32 v134, 16, v31
    v_and_b32 v135, 0xffff0000, v31
    v_pk_fma_f32 v[122:123], v[134:135], v[78:79], v[122:123] op_sel:[0,0,0] op_sel_hi:[1,0,1]
    v_pk_fma_f32 v[130:131], v[134:135], v[78:79], v[130:131] op_sel:[0,1,0] op_sel_hi:[1,1,1]
    v_lshlrev_b32 v132, 16, v32
    v_and_b32 v133, 0xffff0000, v32
    v_pk_fma_f32 v[116:117], v[132:133], v[80:81], v[116:117] op_sel:[0,0,0] op_sel_hi:[1,0,1]
    v_pk_fma_f32 v[124:125], v[132:133], v[80:81], v[124:125] op_sel:[0,1,0] op_sel_hi:[1,1,1]
    v_lshlrev_b32 v134, 16, v33
    v_and_b32 v135, 0xffff0000, v33
    v_pk_fma_f32 v[118:119], v[134:135], v[80:81], v[118:119] op_sel:[0,0,0] op_sel_hi:[1,0,1]
    v_pk_fma_f32 v[126:127], v[134:135], v[80:81], v[126:127] op_sel:[0,1,0] op_sel_hi:[1,1,1]
    v_lshlrev_b32 v132, 16, v34
    v_and_b32 v133, 0xffff0000, v34
    v_pk_fma_f32 v[120:121], v[132:133], v[80:81], v[120:121] op_sel:[0,0,0] op_sel_hi:[1,0,1]
    v_pk_fma_f32 v[128:129], v[132:133], v[80:81], v[128:129] op_sel:[0,1,0] op_sel_hi:[1,1,1]
    v_lshlrev_b32 v134, 16, v35
    v_and_b32 v135, 0xffff0000, v35
    v_pk_fma_f32 v[122:123], v[134:135], v[80:81], v[122:123] op_sel:[0,0,0] op_sel_hi:[1,0,1]
    v_pk_fma_f32 v[130:131], v[134:135], v[80:81], v[130:131] op_sel:[0,1,0] op_sel_hi:[1,1,1]
    v_lshlrev_b32 v132, 16, v36
    v_and_b32 v133, 0xffff0000, v36
    v_pk_fma_f32 v[116:117], v[132:133], v[82:83], v[116:117] op_sel:[0,0,0] op_sel_hi:[1,0,1]
    v_pk_fma_f32 v[124:125], v[132:133], v[82:83], v[124:125] op_sel:[0,1,0] op_sel_hi:[1,1,1]
    v_lshlrev_b32 v134, 16, v37
    v_and_b32 v135, 0xffff0000, v37
    v_pk_fma_f32 v[118:119], v[134:135], v[82:83], v[118:119] op_sel:[0,0,0] op_sel_hi:[1,0,1]
    v_pk_fma_f32 v[126:127], v[134:135], v[82:83], v[126:127] op_sel:[0,1,0] op_sel_hi:[1,1,1]
    v_lshlrev_b32 v132, 16, v38
    v_and_b32 v133, 0xffff0000, v38
    v_pk_fma_f32 v[120:121], v[132:133], v[82:83], v[120:121] op_sel:[0,0,0] op_sel_hi:[1,0,1]
    v_pk_fma_f32 v[128:129], v[132:133], v[82:83], v[128:129] op_sel:[0,1,0] op_sel_hi:[1,1,1]
    v_lshlrev_b32 v134, 16, v39
    v_and_b32 v135, 0xffff0000, v39
    v_pk_fma_f32 v[122:123], v[134:135], v[82:83], v[122:123] op_sel:[0,0,0] op_sel_hi:[1,0,1]
    v_pk_fma_f32 v[130:131], v[134:135], v[82:83], v[130:131] op_sel:[0,1,0] op_sel_hi:[1,1,1]
    v_lshlrev_b32 v132, 16, v40
    v_and_b32 v133, 0xffff0000, v40
    v_pk_fma_f32 v[116:117], v[132:133], v[84:85], v[116:117] op_sel:[0,0,0] op_sel_hi:[1,0,1]
    v_pk_fma_f32 v[124:125], v[132:133], v[84:85], v[124:125] op_sel:[0,1,0] op_sel_hi:[1,1,1]
    v_lshlrev_b32 v134, 16, v41
    v_and_b32 v135, 0xffff0000, v41
    v_pk_fma_f32 v[118:119], v[134:135], v[84:85], v[118:119] op_sel:[0,0,0] op_sel_hi:[1,0,1]
    v_pk_fma_f32 v[126:127], v[134:135], v[84:85], v[126:127] op_sel:[0,1,0] op_sel_hi:[1,1,1]
    v_lshlrev_b32 v132, 16, v42
    v_and_b32 v133, 0xffff0000, v42
    v_pk_fma_f32 v[120:121], v[132:133], v[84:85], v[120:121] op_sel:[0,0,0] op_sel_hi:[1,0,1]
    v_pk_fma_f32 v[128:129], v[132:133], v[84:85], v[128:129] op_sel:[0,1,0] op_sel_hi:[1,1,1]
    v_lshlrev_b32 v134, 16, v43
    v_and_b32 v135, 0xffff0000, v43
    v_pk_fma_f32 v[122:123], v[134:135], v[84:85], v[122:123] op_sel:[0,0,0] op_sel_hi:[1,0,1]
    v_pk_fma_f32 v[130:131], v[134:135], v[84:85], v[130:131] op_sel:[0,1,0] op_sel_hi:[1,1,1]
    v_lshlrev_b32 v132, 16, v44
    v_and_b32 v133, 0xffff0000, v44
    v_pk_fma_f32 v[116:117], v[132:133], v[86:87], v[116:117] op_sel:[0,0,0] op_sel_hi:[1,0,1]
    v_pk_fma_f32 v[124:125], v[132:133], v[86:87], v[124:125] op_sel:[0,1,0] op_sel_hi:[1,1,1]
    v_lshlrev_b32 v134, 16, v45
    v_and_b32 v135, 0xffff0000, v45
    v_pk_fma_f32 v[118:119], v[134:135], v[86:87], v[118:119] op_sel:[0,0,0] op_sel_hi:[1,0,1]
    v_pk_fma_f32 v[126:127], v[134:135], v[86:87], v[126:127] op_sel:[0,1,0] op_sel_hi:[1,1,1]
    v_lshlrev_b32 v132, 16, v46
    v_and_b32 v133, 0xffff0000, v46
    v_pk_fma_f32 v[120:121], v[132:133], v[86:87], v[120:121] op_sel:[0,0,0] op_sel_hi:[1,0,1]
    v_pk_fma_f32 v[128:129], v[132:133], v[86:87], v[128:129] op_sel:[0,1,0] op_sel_hi:[1,1,1]
    v_lshlrev_b32 v134, 16, v47
    v_and_b32 v135, 0xffff0000, v47
    v_pk_fma_f32 v[122:123], v[134:135], v[86:87], v[122:123] op_sel:[0,0,0] op_sel_hi:[1,0,1]
    v_pk_fma_f32 v[130:131], v[134:135], v[86:87], v[130:131] op_sel:[0,1,0] op_sel_hi:[1,1,1]
    v_lshlrev_b32 v132, 16, v48
    v_and_b32 v133, 0xffff0000, v48
    v_pk_fma_f32 v[116:117], v[132:133], v[88:89], v[116:117] op_sel:[0,0,0] op_sel_hi:[1,0,1]
    v_pk_fma_f32 v[124:125], v[132:133], v[88:89], v[124:125] op_sel:[0,1,0] op_sel_hi:[1,1,1]
    v_lshlrev_b32 v134, 16, v49
    v_and_b32 v135, 0xffff0000, v49
    v_pk_fma_f32 v[118:119], v[134:135], v[88:89], v[118:119] op_sel:[0,0,0] op_sel_hi:[1,0,1]
    v_pk_fma_f32 v[126:127], v[134:135], v[88:89], v[126:127] op_sel:[0,1,0] op_sel_hi:[1,1,1]
    v_lshlrev_b32 v132, 16, v50
    v_and_b32 v133, 0xffff0000, v50
    v_pk_fma_f32 v[120:121], v[132:133], v[88:89], v[120:121] op_sel:[0,0,0] op_sel_hi:[1,0,1]
    v_pk_fma_f32 v[128:129], v[132:133], v[88:89], v[128:129] op_sel:[0,1,0] op_sel_hi:[1,1,1]
    v_lshlrev_b32 v134, 16, v51
    v_and_b32 v135, 0xffff0000, v51
    v_pk_fma_f32 v[122:123], v[134:135], v[88:89], v[122:123] op_sel:[0,0,0] op_sel_hi:[1,0,1]
    v_pk_fma_f32 v[130:131], v[134:135], v[88:89], v[130:131] op_sel:[0,1,0] op_sel_hi:[1,1,1]
    v_lshlrev_b32 v132, 16, v52
    v_and_b32 v133, 0xffff0000, v52
    v_pk_fma_f32 v[116:117], v[132:133], v[90:91], v[116:117] op_sel:[0,0,0] op_sel_hi:[1,0,1]
    v_pk_fma_f32 v[124:125], v[132:133], v[90:91], v[124:125] op_sel:[0,1,0] op_sel_hi:[1,1,1]
    v_lshlrev_b32 v134, 16, v53
    v_and_b32 v135, 0xffff0000, v53
    v_pk_fma_f32 v[118:119], v[134:135], v[90:91], v[118:119] op_sel:[0,0,0] op_sel_hi:[1,0,1]
    v_pk_fma_f32 v[126:127], v[134:135], v[90:91], v[126:127] op_sel:[0,1,0] op_sel_hi:[1,1,1]
    v_lshlrev_b32 v132, 16, v54
    v_and_b32 v133, 0xffff0000, v54
    v_pk_fma_f32 v[120:121], v[132:133], v[90:91], v[120:121] op_sel:[0,0,0] op_sel_hi:[1,0,1]
    v_pk_fma_f32 v[128:129], v[132:133], v[90:91], v[128:129] op_sel:[0,1,0] op_sel_hi:[1,1,1]
    v_lshlrev_b32 v134, 16, v55
    v_and_b32 v135, 0xffff0000, v55
    v_pk_fma_f32 v[122:123], v[134:135], v[90:91], v[122:123] op_sel:[0,0,0] op_sel_hi:[1,0,1]
    v_pk_fma_f32 v[130:131], v[134:135], v[90:91], v[130:131] op_sel:[0,1,0] op_sel_hi:[1,1,1]
    v_lshlrev_b32 v132, 16, v56
    v_and_b32 v133, 0xffff0000, v56
    v_pk_fma_f32 v[116:117], v[132:133], v[92:93], v[116:117] op_sel:[0,0,0] op_sel_hi:[1,0,1]
    v_pk_fma_f32 v[124:125], v[132:133], v[92:93], v[124:125] op_sel:[0,1,0] op_sel_hi:[1,1,1]
    v_lshlrev_b32 v134, 16, v57
    v_and_b32 v135, 0xffff0000, v57
    v_pk_fma_f32 v[118:119], v[134:135], v[92:93], v[118:119] op_sel:[0,0,0] op_sel_hi:[1,0,1]
    v_pk_fma_f32 v[126:127], v[134:135], v[92:93], v[126:127] op_sel:[0,1,0] op_sel_hi:[1,1,1]
    v_lshlrev_b32 v132, 16, v58
    v_and_b32 v133, 0xffff0000, v58
    v_pk_fma_f32 v[120:121], v[132:133], v[92:93], v[120:121] op_sel:[0,0,0] op_sel_hi:[1,0,1]
    v_pk_fma_f32 v[128:129], v[132:133], v[92:93], v[128:129] op_sel:[0,1,0] op_sel_hi:[1,1,1]
    v_lshlrev_b32 v134, 16, v59
    v_and_b32 v135, 0xffff0000, v59
    v_pk_fma_f32 v[122:123], v[134:135], v[92:93], v[122:123] op_sel:[0,0,0] op_sel_hi:[1,0,1]
    v_pk_fma_f32 v[130:131], v[134:135], v[92:93], v[130:131] op_sel:[0,1,0] op_sel_hi:[1,1,1]
    v_lshlrev_b32 v132, 16, v60
    v_and_b32 v133, 0xffff0000, v60
    v_pk_fma_f32 v[116:117], v[132:133], v[94:95], v[116:117] op_sel:[0,0,0] op_sel_hi:[1,0,1]
    v_pk_fma_f32 v[124:125], v[132:133], v[94:95], v[124:125] op_sel:[0,1,0] op_sel_hi:[1,1,1]
    v_lshlrev_b32 v134, 16, v61
    v_and_b32 v135, 0xffff0000, v61
    v_pk_fma_f32 v[118:119], v[134:135], v[94:95], v[118:119] op_sel:[0,0,0] op_sel_hi:[1,0,1]
    v_pk_fma_f32 v[126:127], v[134:135], v[94:95], v[126:127] op_sel:[0,1,0] op_sel_hi:[1,1,1]
    v_lshlrev_b32 v132, 16, v62
    v_and_b32 v133, 0xffff0000, v62
    v_pk_fma_f32 v[120:121], v[132:133], v[94:95], v[120:121] op_sel:[0,0,0] op_sel_hi:[1,0,1]
    v_pk_fma_f32 v[128:129], v[132:133], v[94:95], v[128:129] op_sel:[0,1,0] op_sel_hi:[1,1,1]
    v_lshlrev_b32 v134, 16, v63
    v_and_b32 v135, 0xffff0000, v63
    v_pk_fma_f32 v[122:123], v[134:135], v[94:95], v[122:123] op_sel:[0,0,0] op_sel_hi:[1,0,1]
    v_pk_fma_f32 v[130:131], v[134:135], v[94:95], v[130:131] op_sel:[0,1,0] op_sel_hi:[1,1,1]
    v_lshlrev_b32 v132, 16, v64
    v_and_b32 v133, 0xffff0000, v64
    v_pk_fma_f32 v[116:117], v[132:133], v[96:97], v[116:117] op_sel:[0,0,0] op_sel_hi:[1,0,1]
    v_pk_fma_f32 v[124:125], v[132:133], v[96:97], v[124:125] op_sel:[0,1,0] op_sel_hi:[1,1,1]
    v_lshlrev_b32 v134, 16, v65
    v_and_b32 v135, 0xffff0000, v65
    v_pk_fma_f32 v[118:119], v[134:135], v[96:97], v[118:119] op_sel:[0,0,0] op_sel_hi:[1,0,1]
    v_pk_fma_f32 v[126:127], v[134:135], v[96:97], v[126:127] op_sel:[0,1,0] op_sel_hi:[1,1,1]
    v_lshlrev_b32 v132, 16, v66
    v_and_b32 v133, 0xffff0000, v66
    v_pk_fma_f32 v[120:121], v[132:133], v[96:97], v[120:121] op_sel:[0,0,0] op_sel_hi:[1,0,1]
    v_pk_fma_f32 v[128:129], v[132:133], v[96:97], v[128:129] op_sel:[0,1,0] op_sel_hi:[1,1,1]
    v_lshlrev_b32 v134, 16, v67
    v_and_b32 v135, 0xffff0000, v67
    v_pk_fma_f32 v[122:123], v[134:135], v[96:97], v[122:123] op_sel:[0,0,0] op_sel_hi:[1,0,1]
    v_pk_fma_f32 v[130:131], v[134:135], v[96:97], v[130:131] op_sel:[0,1,0] op_sel_hi:[1,1,1]
    v_lshlrev_b32 v132, 16, v68
    v_and_b32 v133, 0xffff0000, v68
    v_pk_fma_f32 v[116:117], v[132:133], v[98:99], v[116:117] op_sel:[0,0,0] op_sel_hi:[1,0,1]
    v_pk_fma_f32 v[124:125], v[132:133], v[98:99], v[124:125] op_sel:[0,1,0] op_sel_hi:[1,1,1]
    v_lshlrev_b32 v134, 16, v69
    v_and_b32 v135, 0xffff0000, v69
    v_pk_fma_f32 v[118:119], v[134:135], v[98:99], v[118:119] op_sel:[0,0,0] op_sel_hi:[1,0,1]
    v_pk_fma_f32 v[126:127], v[134:135], v[98:99], v[126:127] op_sel:[0,1,0] op_sel_hi:[1,1,1]
    v_lshlrev_b32 v132, 16, v70
    v_and_b32 v133, 0xffff0000, v70
    v_pk_fma_f32 v[120:121], v[132:133], v[98:99], v[120:121] op_sel:[0,0,0] op_sel_hi:[1,0,1]
    v_pk_fma_f32 v[128:129], v[132:133], v[98:99], v[128:129] op_sel:[0,1,0] op_sel_hi:[1,1,1]
    v_lshlrev_b32 v134, 16, v71
    v_and_b32 v135, 0xffff0000, v71
    v_pk_fma_f32 v[122:123], v[134:135], v[98:99], v[122:123] op_sel:[0,0,0] op_sel_hi:[1,0,1]
    v_pk_fma_f32 v[130:131], v[134:135], v[98:99], v[130:131] op_sel:[0,1,0] op_sel_hi:[1,1,1]
    v_permlane32_swap_b32 v116, v124
    v_permlane32_swap_b32 v117, v125
    v_permlane32_swap_b32 v118, v126
    v_permlane32_swap_b32 v119, v127
    v_permlane32_swap_b32 v120, v128
    v_permlane32_swap_b32 v121, v129
    v_permlane32_swap_b32 v122, v130
    v_permlane32_swap_b32 v123, v131
    v_add_f32 v116, v116, v124
    v_add_f32 v117, v117, v125
    v_add_f32 v118, v118, v126
    v_add_f32 v119, v119, v127
    v_add_f32 v120, v120, v128
    v_add_f32 v121, v121, v129
    v_add_f32 v122, v122, v130
    v_add_f32 v123, v123, v131
    v_permlane16_swap_b32 v116, v120
    v_permlane16_swap_b32 v117, v121
    v_permlane16_swap_b32 v118, v122
    v_permlane16_swap_b32 v119, v123
    v_add_f32 v116, v116, v120
    v_add_f32 v117, v117, v121
    v_add_f32 v118, v118, v122
    v_add_f32 v119, v119, v123
    v_add_f32_dpp v116, v116, v116 row_ror:8 row_mask:0xf bank_mask:0x3
    v_add_f32_dpp v117, v117, v117 row_ror:8 row_mask:0xf bank_mask:0x3
    v_add_f32_dpp v116, v118, v118 row_ror:8 row_mask:0xf bank_mask:0xc
    v_add_f32_dpp v117, v119, v119 row_ror:8 row_mask:0xf bank_mask:0xc
    v_lshrrev_b32 v5, 5, v1
    v_lshlrev_b32 v5, 15, v5
    v_and_b32 v6, 7, v1
    v_lshl_add_u32 v5, v6, 6, v5
    v_bfe_u32 v6, v1, 3, 2
    v_lshl_add_u32 v5, v6, 4, v5
    s_lshl_b32 s84, s78, 16
    s_lshl_b32 s85, s73, 12
    s_add_u32 s84, s84, s85
    s_lshl_b32 s85, s79, 9
    s_add_u32 s84, s84, s85
    v_or_b32 v142, v142, v141
    s_cmp_lg_u32 s89, 0
    s_cbranch_scc1 L_non_ok
    v_readfirstlane_b32 s89, v142
    s_nop 0
    s_cmp_lg_u32 s89, 0
    s_cbranch_scc1 L_non_ok
    s_waitcnt vmcnt(0)
    v_mov_b32 v142, v140
    s_cmp_lg_u32 s89, 0
    s_cbranch_scc1 L_non_ok
L_pollN:
    s_nop 4
    v_readfirstlane_b32 s89, v142
    s_nop 0
    s_cmp_lg_u32 s89, 0
    s_cbranch_scc1 L_non_ok
    s_sub_u32 s87, s87, 1
    s_cmp_eq_u32 s87, 0
    s_cbranch_scc1 L_non_ok
    buffer_load_dword v142, v143, s[64:67], 0 offen sc1
    s_waitcnt vmcnt(0)
    s_branch L_pollN
L_non_ok:
    s_nop 4
    v_mov_b32 v132, v116
    v_mov_b32 v133, s89
    v_mov_b32 v134, v117
    v_mov_b32 v135, s89
    buffer_store_dwordx4 v[132:135], v5, s[36:39], s84 offen
    s_add_u32 s84, s84, 262144
    buffer_store_dwordx4 v[132:135], v5, s[36:39], s84 offen sc1
    s_getreg_b32 s101, hwreg(HW_REG_XCC_ID)
    s_and_b32 s101, s101, 15
    v_mov_b32 v136, s89
    v_mov_b32 v137, s101
    s_lshl_b32 s84, s73, 5
    s_add_u32 s84, s84, s91
    s_lshl_b32 s84, s84, 3
    s_add_u32 s84, s84, 1384448
    s_mov_b64 exec, 1
    buffer_store_dwordx2 v[136:137], v143, s[36:39], s84 offen sc1
    s_mov_b64 exec, -1
    v_lshlrev_b32 v5, 4, v1
    s_lshl_b32 s78, s72, 15
    s_lshl_b32 s85, s73, 12
    s_add_u32 s78, s78, s85
    s_mov_b32 s79, 0
L_pollQ:
    s_nop 4
    s_and_b32 s85, s79, 3
    s_cmp_eq_u32 s85, 3
    s_cselect_b32 s84, 262144, 0
    s_add_u32 s84, s84, s78
    s_add_u32 s79, s79, 1
    buffer_load_dwordx4 v[16:19], v5, s[36:39], s84 offen offset:0 sc1
    buffer_load_dwordx4 v[20:23], v5, s[36:39], s84 offen offset:1024 sc1
    buffer_load_dwordx4 v[24:27], v5, s[36:39], s84 offen offset:2048 sc1
    buffer_load_dwordx4 v[28:31], v5, s[36:39], s84 offen offset:3072 sc1
    s_add_u32 s84, s84, 65536
    buffer_load_dwordx4 v[32:35], v5, s[36:39], s84 offen offset:0 sc1
    buffer_load_dwordx4 v[36:39], v5, s[36:39], s84 offen offset:1024 sc1
    buffer_load_dwordx4 v[40:43], v5, s[36:39], s84 offen offset:2048 sc1
    buffer_load_dwordx4 v[44:47], v5, s[36:39], s84 offen offset:3072 sc1
    s_add_u32 s84, s84, 65536
    buffer_load_dwordx4 v[48:51], v5, s[36:39], s84 offen offset:0 sc1
    buffer_load_dwordx4 v[52:55], v5, s[36:39], s84 offen offset:1024 sc1
    buffer_load_dwordx4 v[56:59], v5, s[36:39], s84 offen offset:2048 sc1
    buffer_load_dwordx4 v[60:63], v5, s[36:39], s84 offen offset:3072 sc1
    s_add_u32 s84, s84, 65536
    buffer_load_dwordx4 v[64:67], v5, s[36:39], s84 offen offset:0 sc1
    buffer_load_dwordx4 v[68:71], v5, s[36:39], s84 offen offset:1024 sc1
    buffer_load_dwordx4 v[72:75], v5, s[36:39], s84 offen offset:2048 sc1
    buffer_load_dwordx4 v[76:79], v5, s[36:39], s84 offen offset:3072 sc1
    s_waitcnt vmcnt(0)
    v_xor_b32 v8, s89, v17
    v_xor_b32 v9, s89, v19
    v_or_b32 v8, v8, v9
    v_xor_b32 v9, s89, v21
    v_or_b32 v8, v8, v9
    v_xor_b32 v9, s89, v23
    v_or_b32 v8, v8, v9
    v_xor_b32 v9, s89, v25
    v_or_b32 v8, v8, v9
    v_xor_b32 v9, s89, v27
    v_or_b32 v8, v8, v9
    v_xor_b32 v9, s89, v29
    v_or_b32 v8, v8, v9
    v_xor_b32 v9, s89, v31
    v_or_b32 v8, v8, v9
    v_xor_b32 v9, s89, v33
    v_or_b32 v8, v8, v9
    v_xor_b32 v9, s89, v35
    v_or_b32 v8, v8, v9
    v_xor_b32 v9, s89, v37
    v_or_b32 v8, v8, v9
    v_xor_b32 v9, s89, v39
    v_or_b32 v8, v8, v9
    v_xor_b32 v9, s89, v41
    v_or_b32 v8, v8, v9
    v_xor_b32 v9, s89, v43
    v_or_b32 v8, v8, v9
    v_xor_b32 v9, s89, v45
    v_or_b32 v8, v8, v9
    v_xor_b32 v9, s89, v47
    v_or_b32 v8, v8, v9
    v_xor_b32 v9, s89, v49
    v_or_b32 v8, v8, v9
    v_xor_b32 v9, s89, v51
    v_or_b32 v8, v8, v9
    v_xor_b32 v9, s89, v53
    v_or_b32 v8, v8, v9
    v_xor_b32 v9, s89, v55
    v_or_b32 v8, v8, v9
    v_xor_b32 v9, s89, v57
    v_or_b32 v8, v8, v9
    v_xor_b32 v9, s89, v59
    v_or_b32 v8, v8, v9
    v_xor_b32 v9, s89, v61
    v_or_b32 v8, v8, v9
    v_xor_b32 v9, s89, v63
    v_or_b32 v8, v8, v9
    v_xor_b32 v9, s89, v65
    v_or_b32 v8, v8, v9
    v_xor_b32 v9, s89, v67
    v_or_b32 v8, v8, v9
    v_xor_b32 v9, s89, v69
    v_or_b32 v8, v8, v9
    v_xor_b32 v9, s89, v71
    v_or_b32 v8, v8, v9
    v_xor_b32 v9, s89, v73
    v_or_b32 v8, v8, v9
    v_xor_b32 v9, s89, v75
    v_or_b32 v8, v8, v9
    v_xor_b32 v9, s89, v77
    v_or_b32 v8, v8, v9
    v_xor_b32 v9, s89, v79
    v_or_b32 v8, v8, v9
    v_cmp_ne_u32 vcc, 0, v8
    s_sub_u32 s87, s87, 1
    s_cmp_eq_u32 s87, 0
    s_cbranch_scc1 L_pollQ_x
    s_mov_b64 exec, vcc
    s_cbranch_vccnz L_pollQ
L_pollQ_x:
    s_nop 4
    s_mov_b64 exec, -1
    v_add_f32 v16, v16, v32
    v_add_f32 v48, v48, v64
    v_add_f32 v18, v18, v34
    v_add_f32 v50, v50, v66
    v_add_f32 v20, v20, v36
    v_add_f32 v52, v52, v68
    v_add_f32 v22, v22, v38
    v_add_f32 v54, v54, v70
    v_add_f32 v24, v24, v40
    v_add_f32 v56, v56, v72
    v_add_f32 v26, v26, v42
    v_add_f32 v58, v58, v74
    v_add_f32 v28, v28, v44
    v_add_f32 v60, v60, v76
    v_add_f32 v30, v30, v46
    v_add_f32 v62, v62, v78
    v_add_f32 v16, v16, v48
    v_add_f32 v18, v18, v50
    v_add_f32 v20, v20, v52
    v_add_f32 v22, v22, v54
    v_add_f32 v24, v24, v56
    v_add_f32 v26, v26, v58
    v_add_f32 v28, v28, v60
    v_add_f32 v30, v30, v62
    v_cvt_pk_bf16_f32 v8, v16, v18
    v_cvt_pk_bf16_f32 v9, v20, v22
    v_cvt_pk_bf16_f32 v10, v24, v26
    v_cvt_pk_bf16_f32 v11, v28, v30
    v_lshlrev_b32 v6, 2, v1
    ds_write_b32 v6, v8 offset:0
    ds_write_b32 v6, v9 offset:256
    ds_write_b32 v6, v10 offset:512
    ds_write_b32 v6, v11 offset:768
    s_waitcnt lgkmcnt(0)
    s_mov_b32 s84, 1384448
    v_lshlrev_b32 v5, 5, v1
    buffer_load_dwordx4 v[8:11], v5, s[36:39], s84 offen sc1
    buffer_load_dwordx4 v[12:15], v5, s[36:39], s84 offen offset:16 sc1
    s_barrier
    s_barrier
    s_mov_b32 s97, 1
    s_branch L_pollG_chk
L_pollG:
    s_nop 4
    s_mov_b32 s97, 0
    buffer_load_dwordx4 v[8:11], v5, s[36:39], s84 offen sc1
    buffer_load_dwordx4 v[12:15], v5, s[36:39], s84 offen offset:16 sc1
L_pollG_chk:
    s_nop 4
    s_waitcnt vmcnt(0)
    v_xor_b32 v16, s89, v8
    v_xor_b32 v17, s89, v10
    v_xor_b32 v18, s89, v12
    v_xor_b32 v19, s89, v14
    v_or3_b32 v16, v16, v17, v18
    v_or_b32 v16, v16, v19
    v_cmp_ne_u32 vcc, 0, v16
    s_sub_u32 s87, s87, 1
    s_cmp_eq_u32 s87, 0
    s_cbranch_scc1 L_pollG_x
    s_cbranch_vccnz L_pollG
L_pollG_x:
    s_nop 4
    v_xor_b32 v16, s101, v9
    v_xor_b32 v17, s101, v11
    v_xor_b32 v18, s101, v13
    v_xor_b32 v19, s101, v15
    v_or3_b32 v16, v16, v17, v18
    v_or_b32 v16, v16, v19
    v_lshrrev_b32 v17, 3, v1
    v_cmp_eq_u32 vcc, s73, v17
    s_nop 1
    v_cndmask_b32 v16, 0, v16, vcc
    v_cmp_ne_u32 vcc, 0, v16
    s_nop 1
    s_cmp_eq_u64 vcc, 0
    s_cselect_b32 s84, 0, 327680
    v_mov_b32 v16, s84
    ds_write_b32 v143, v16 offset:3264
    s_waitcnt lgkmcnt(0)
    s_barrier
    s_cmp_eq_u32 s100, 0
    s_cbranch_scc1 L_aux_end
    v_lshlrev_b32 v7, 4, v1
    s_mul_i32 s78, s77, 57344
    s_mov_b32 s79, 70656
    s_mov_b32 m0, s79
    s_nop 0
    buffer_load_dwordx4 v7, s[52:55], s78 offen nt lds
    s_add_u32 s78, s78, 1024
    s_add_u32 s79, s79, 1024
    s_mov_b32 m0, s79
    s_nop 0
    buffer_load_dwordx4 v7, s[52:55], s78 offen nt lds
    s_add_u32 s78, s78, 1024
    s_add_u32 s79, s79, 1024
    s_mov_b32 m0, s79
    s_nop 0
    buffer_load_dwordx4 v7, s[52:55], s78 offen nt lds
    s_add_u32 s78, s78, 1024
    s_add_u32 s79, s79, 1024
    s_mov_b32 m0, s79
    s_nop 0
    buffer_load_dwordx4 v7, s[52:55], s78 offen nt lds
    s_add_u32 s78, s78, 1024
    s_add_u32 s79, s79, 1024
    s_mov_b32 m0, s79
    s_nop 0
    buffer_load_dwordx4 v7, s[52:55], s78 offen nt lds
    s_add_u32 s78, s78, 1024
    s_add_u32 s79, s79, 1024
    s_mov_b32 m0, s79
    s_nop 0
    buffer_load_dwordx4 v7, s[52:55], s78 offen nt lds
    s_add_u32 s78, s78, 1024
    s_add_u32 s79, s79, 1024
    s_mov_b32 m0, s79
    s_nop 0
    buffer_load_dwordx4 v7, s[52:55], s78 offen nt lds
    s_add_u32 s78, s78, 1024
    s_add_u32 s79, s79, 1024
    s_mov_b32 m0, s79
    s_nop 0
    buffer_load_dwordx4 v7, s[52:55], s78 offen nt lds
    s_add_u32 s78, s78, 1024
    s_add_u32 s79, s79, 1024
    s_mov_b32 m0, s79
    s_nop 0
    buffer_load_dwordx4 v7, s[52:55], s78 offen nt lds
    s_add_u32 s78, s78, 1024
    s_add_u32 s79, s79, 1024
    s_mov_b32 m0, s79
    s_nop 0
    buffer_load_dwordx4 v7, s[52:55], s78 offen nt lds
    s_add_u32 s78, s78, 1024
    s_add_u32 s79, s79, 1024
    s_mov_b32 m0, s79
    s_nop 0
    buffer_load_dwordx4 v7, s[52:55], s78 offen nt lds
    s_add_u32 s78, s78, 1024
    s_add_u32 s79, s79, 1024
    s_mov_b32 m0, s79
    s_nop 0
    buffer_load_dwordx4 v7, s[52:55], s78 offen nt lds
    s_add_u32 s78, s78, 1024
    s_add_u32 s79, s79, 1024
    s_mov_b32 m0, s79
    s_nop 0
    buffer_load_dwordx4 v7, s[52:55], s78 offen nt lds
    s_add_u32 s78, s78, 1024
    s_add_u32 s79, s79, 1024
    s_mov_b32 m0, s79
    s_nop 0
    buffer_load_dwordx4 v7, s[52:55], s78 offen nt lds
    s_add_u32 s78, s78, 1024
    s_add_u32 s79, s79, 1024
    s_mov_b32 m0, s79
    s_nop 0
    buffer_load_dwordx4 v7, s[52:55], s78 offen nt lds
    s_add_u32 s78, s78, 1024
    s_add_u32 s79, s79, 1024
    s_mov_b32 m0, s79
    s_nop 0
    buffer_load_dwordx4 v7, s[52:55], s78 offen nt lds
    s_add_u32 s78, s78, 1024
    s_add_u32 s79, s79, 1024
    s_mov_b32 m0, s79
    s_nop 0
    buffer_load_dwordx4 v7, s[52:55], s78 offen nt lds
    s_add_u32 s78, s78, 1024
    s_add_u32 s79, s79, 1024
    s_mov_b32 m0, s79
    s_nop 0
    buffer_load_dwordx4 v7, s[52:55], s78 offen nt lds
    s_add_u32 s78, s78, 1024
    s_add_u32 s79, s79, 1024
    s_mov_b32 m0, s79
    s_nop 0
    buffer_load_dwordx4 v7, s[52:55], s78 offen nt lds
    s_add_u32 s78, s78, 1024
    s_add_u32 s79, s79, 1024
    s_mov_b32 m0, s79
    s_nop 0
    buffer_load_dwordx4 v7, s[52:55], s78 offen nt lds
    s_add_u32 s78, s78, 1024
    s_add_u32 s79, s79, 1024
    s_mov_b32 m0, s79
    s_nop 0
    buffer_load_dwordx4 v7, s[52:55], s78 offen nt lds
    s_add_u32 s78, s78, 1024
    s_add_u32 s79, s79, 1024
    s_mov_b32 m0, s79
    s_nop 0
    buffer_load_dwordx4 v7, s[52:55], s78 offen nt lds
    s_add_u32 s78, s78, 1024
    s_add_u32 s79, s79, 1024
    s_mov_b32 m0, s79
    s_nop 0
    buffer_load_dwordx4 v7, s[52:55], s78 offen nt lds
    s_add_u32 s78, s78, 1024
    s_add_u32 s79, s79, 1024
    s_mov_b32 m0, s79
    s_nop 0
    buffer_load_dwordx4 v7, s[52:55], s78 offen nt lds
    s_add_u32 s78, s78, 1024
    s_add_u32 s79, s79, 1024
    s_mov_b32 m0, s79
    s_nop 0
    buffer_load_dwordx4 v7, s[52:55], s78 offen nt lds
    s_add_u32 s78, s78, 1024
    s_add_u32 s79, s79, 1024
    s_mov_b32 m0, s79
    s_nop 0
    buffer_load_dwordx4 v7, s[52:55], s78 offen nt lds
    s_add_u32 s78, s78, 1024
    s_add_u32 s79, s79, 1024
    s_mov_b32 m0, s79
    s_nop 0
    buffer_load_dwordx4 v7, s[52:55], s78 offen nt lds
    s_add_u32 s78, s78, 1024
    s_add_u32 s79, s79, 1024
    s_mov_b32 m0, s79
    s_nop 0
    buffer_load_dwordx4 v7, s[52:55], s78 offen nt lds
    s_add_u32 s78, s78, 1024
    s_add_u32 s79, s79, 1024
    s_mov_b32 m0, s79
    s_nop 0
    buffer_load_dwordx4 v7, s[52:55], s78 offen nt lds
    s_add_u32 s78, s78, 1024
    s_add_u32 s79, s79, 1024
    s_mov_b32 m0, s79
    s_nop 0
    buffer_load_dwordx4 v7, s[52:55], s78 offen nt lds
    s_add_u32 s78, s78, 1024
    s_add_u32 s79, s79, 1024
    s_mov_b32 m0, s79
    s_nop 0
    buffer_load_dwordx4 v7, s[52:55], s78 offen nt lds
    s_add_u32 s78, s78, 1024
    s_add_u32 s79, s79, 1024
    s_mov_b32 m0, s79
    s_nop 0
    buffer_load_dwordx4 v7, s[52:55], s78 offen nt lds
    s_add_u32 s78, s78, 1024
    s_add_u32 s79, s79, 1024
    s_mov_b32 m0, s79
    s_nop 0
    buffer_load_dwordx4 v7, s[52:55], s78 offen nt lds
    s_add_u32 s78, s78, 1024
    s_add_u32 s79, s79, 1024
    s_mov_b32 m0, s79
    s_nop 0
    buffer_load_dwordx4 v7, s[52:55], s78 offen nt lds
    s_add_u32 s78, s78, 1024
    s_add_u32 s79, s79, 1024
    s_mov_b32 m0, s79
    s_nop 0
    buffer_load_dwordx4 v7, s[52:55], s78 offen nt lds
    s_add_u32 s78, s78, 1024
    s_add_u32 s79, s79, 1024
    s_mov_b32 m0, s79
    s_nop 0
    buffer_load_dwordx4 v7, s[52:55], s78 offen nt lds
    s_add_u32 s78, s78, 1024
    s_add_u32 s79, s79, 1024
    s_mov_b32 m0, s79
    s_nop 0
    buffer_load_dwordx4 v7, s[52:55], s78 offen nt lds
    s_add_u32 s78, s78, 1024
    s_add_u32 s79, s79, 1024
    s_mov_b32 m0, s79
    s_nop 0
    buffer_load_dwordx4 v7, s[52:55], s78 offen nt lds
    s_add_u32 s78, s78, 1024
    s_add_u32 s79, s79, 1024
    s_mov_b32 m0, s79
    s_nop 0
    buffer_load_dwordx4 v7, s[52:55], s78 offen nt lds
    s_add_u32 s78, s78, 1024
    s_add_u32 s79, s79, 1024
    s_mov_b32 m0, s79
    s_nop 0
    buffer_load_dwordx4 v7, s[52:55], s78 offen nt lds
    s_add_u32 s78, s78, 1024
    s_add_u32 s79, s79, 1024
    s_mov_b32 m0, s79
    s_nop 0
    buffer_load_dwordx4 v7, s[52:55], s78 offen nt lds
    s_add_u32 s78, s78, 1024
    s_add_u32 s79, s79, 1024
    s_mov_b32 m0, s79
    s_nop 0
    buffer_load_dwordx4 v7, s[52:55], s78 offen nt lds
    s_add_u32 s78, s78, 1024
    s_add_u32 s79, s79, 1024
    s_mov_b32 m0, s79
    s_nop 0
    buffer_load_dwordx4 v7, s[52:55], s78 offen nt lds
    s_add_u32 s78, s78, 1024
    s_add_u32 s79, s79, 1024
    s_mov_b32 m0, s79
    s_nop 0
    buffer_load_dwordx4 v7, s[52:55], s78 offen nt lds
    s_add_u32 s78, s78, 1024
    s_add_u32 s79, s79, 1024
    s_mov_b32 m0, s79
    s_nop 0
    buffer_load_dwordx4 v7, s[52:55], s78 offen nt lds
    s_add_u32 s78, s78, 1024
    s_add_u32 s79, s79, 1024
    s_mov_b32 m0, s79
    s_nop 0
    buffer_load_dwordx4 v7, s[52:55], s78 offen nt lds
    s_add_u32 s78, s78, 1024
    s_add_u32 s79, s79, 1024
    s_mov_b32 m0, s79
    s_nop 0
    buffer_load_dwordx4 v7, s[52:55], s78 offen nt lds
    s_add_u32 s78, s78, 1024
    s_add_u32 s79, s79, 1024
    s_mov_b32 m0, s79
    s_nop 0
    buffer_load_dwordx4 v7, s[52:55], s78 offen nt lds
    s_add_u32 s78, s78, 1024
    s_add_u32 s79, s79, 1024
    s_mov_b32 m0, s79
    s_nop 0
    buffer_load_dwordx4 v7, s[52:55], s78 offen nt lds
    s_add_u32 s78, s78, 1024
    s_add_u32 s79, s79, 1024
    s_mov_b32 m0, s79
    s_nop 0
    buffer_load_dwordx4 v7, s[52:55], s78 offen nt lds
    s_add_u32 s78, s78, 1024
    s_add_u32 s79, s79, 1024
    s_mov_b32 m0, s79
    s_nop 0
    buffer_load_dwordx4 v7, s[52:55], s78 offen nt lds
    s_add_u32 s78, s78, 1024
    s_add_u32 s79, s79, 1024
    s_mov_b32 m0, s79
    s_nop 0
    buffer_load_dwordx4 v7, s[52:55], s78 offen nt lds
    s_add_u32 s78, s78, 1024
    s_add_u32 s79, s79, 1024
    s_mov_b32 m0, s79
    s_nop 0
    buffer_load_dwordx4 v7, s[52:55], s78 offen nt lds
    s_add_u32 s78, s78, 1024
    s_add_u32 s79, s79, 1024
    s_mov_b32 m0, s79
    s_nop 0
    buffer_load_dwordx4 v7, s[52:55], s78 offen nt lds
    s_add_u32 s78, s78, 1024
    s_add_u32 s79, s79, 1024
    s_mov_b32 m0, s79
    s_nop 0
    buffer_load_dwordx4 v7, s[52:55], s78 offen nt lds
    s_add_u32 s78, s78, 1024
    s_add_u32 s79, s79, 1024
    s_mov_b32 m0, s79
    s_nop 0
    buffer_load_dwordx4 v7, s[52:55], s78 offen nt lds
    s_barrier
    s_barrier
    s_waitcnt vmcnt(0)
    s_barrier
L_aux_end:
    s_nop 4
    s_endpgm
L_code_end:
.section .rodata,"a"
.p2align 6
.amdhsa_kernel sequential_preLN__gqa_block_cached__dense_activation_silu__decode_kernel
  .amdhsa_next_free_vgpr 168
  .amdhsa_next_free_sgpr 102
  .amdhsa_accum_offset 168
  .amdhsa_group_segment_fixed_size 0
  .amdhsa_kernarg_size 88
  .amdhsa_user_sgpr_count 2
  .amdhsa_user_sgpr_kernarg_segment_ptr 1
  .amdhsa_system_sgpr_workgroup_id_x 1
.end_amdhsa_kernel
```
